```python
import torch

def _softmax(x, axis=-1):
    return torch.softmax(x, dim=axis)
def _gelu(x):
    return torch.nn.functional.gelu(x, approximate="tanh")
def _silu(x):
    return torch.nn.functional.silu(x)
def _sigmoid(x):
    return torch.sigmoid(x)
def _layernorm(x, axis=-1, eps=1e-5):
    m = x.mean(dim=axis, keepdim=True)
    v = x.var(dim=axis, keepdim=True, unbiased=False)
    return (x - m) / torch.sqrt(v + eps)
def _scatter_add(tgt, idx, src, axis=0):
    return tgt.clone().index_add_(axis, idx, src)
def _segment_sum(src, seg, n):
    out = torch.zeros((n,) + src.shape[1:], dtype=src.dtype)
    return out.index_add_(0, seg, src)
def _pad(x, pw):
    flat = tuple(v for pair in reversed(pw) for v in pair)
    return torch.nn.functional.pad(x, flat)

kernel_name = 'gated_mix__mha_block__ssm_conv_s4__prompt'

def setup_inputs():

    _w = (lambda a: (lambda t: t.to(torch.bfloat16) if t.is_floating_point() else t)(torch.as_tensor(a)))
    def _A_setup():
        B, S, D, H = 1, 2048, 448, 16
        return {
            "x": _w((lambda *s: torch.randn(*s, dtype=torch.bfloat16) * 0.05)(B, S, D)),
            "wqkv": _w((lambda *s: torch.randn(*s, dtype=torch.bfloat16) * 0.8)(D, 3 * D)),
            "wo": _w((lambda *s: torch.randn(*s, dtype=torch.bfloat16) * 0.05)(D, D)),
        }
    _A_in = _A_setup()

    def _B_setup():
        B, L, D, N = 1, 2048, 448, 256
        A_re = -(lambda _x: torch.exp(torch.as_tensor(_x)))((lambda *s: torch.randn(*s, dtype=torch.bfloat16) * 6.4)(D, N))
        A_im = torch.pi * (lambda *s: torch.randn(*s, dtype=torch.bfloat16) * 0.1)(D, N)
        B_re = (lambda *s: torch.randn(*s, dtype=torch.bfloat16) * 0.2)(D, N)
        B_im = (lambda *s: torch.randn(*s, dtype=torch.bfloat16) * 0.2)(D, N)
        C_re = (lambda *s: torch.randn(*s, dtype=torch.bfloat16) * 0.2)(D, N)
        C_im = (lambda *s: torch.randn(*s, dtype=torch.bfloat16) * 0.2)(D, N)
        log_dt = (lambda *s: torch.randn(*s, dtype=torch.bfloat16) * 0.1)(D) * 0.5 - 4.0
        Dskip = (lambda *s: torch.randn(*s, dtype=torch.bfloat16) * 0.1)(D)
        return {
            "u": _w((lambda *s: torch.randn(*s, dtype=torch.bfloat16) * 0.05)(B, L, D)),
            "A_re": _w(A_re),
            "A_im": _w(A_im),
            "B_re": _w(B_re),
            "B_im": _w(B_im),
            "C_re": _w(C_re),
            "C_im": _w(C_im),
            "log_dt": _w(log_dt),
            "Dskip": _w(Dskip),
        }
    _B_in = _B_setup()

    return {
        "A_x": _A_in["x"],
        "A_wqkv": _A_in["wqkv"],
        "A_wo": _A_in["wo"],
        "B_u": _B_in["u"],
        "B_A_re": _B_in["A_re"],
        "B_A_im": _B_in["A_im"],
        "B_B_re": _B_in["B_re"],
        "B_B_im": _B_in["B_im"],
        "B_C_re": _B_in["C_re"],
        "B_C_im": _B_in["C_im"],
        "B_log_dt": _B_in["log_dt"],
        "B_Dskip": _B_in["Dskip"],
        "gate_w": _w((lambda *s: torch.randn(*s, dtype=torch.bfloat16) * 0.05)(448) * 16.0),
    }

def reference(A_x, A_wqkv, A_wo, B_u, B_A_re, B_A_im, B_B_re, B_B_im, B_C_re, B_C_im, B_log_dt, B_Dskip, gate_w):
    def _A_ref(x, wqkv, wo):
        B, S, D = x.shape
        H = 16
        Dh = D // H
        qkv = (lambda x, *d: x.permute(*d))((x @ wqkv).reshape(B, S, 3, H, Dh), 2, 0, 3, 1, 4)
        q, k, v = qkv[0], qkv[1], qkv[2]
        scores = torch.einsum("bhqd,bhkd->bhqk", q, k) * (Dh ** -0.5)
        p = _softmax(scores, axis=-1)
        o = torch.einsum("bhqk,bhkd->bhqd", p, v)
        return (lambda x, *d: x.permute(*d))(o, 0, 2, 1, 3).reshape(B, S, D) @ wo

    def _B_ref(u, A_re, A_im, B_re, B_im, C_re, C_im, log_dt, Dskip):
        Bsz, L, D = u.shape
        dt = torch.exp(log_dt)[:, None]
        A = A_re + 1j * A_im
        Bc = B_re + 1j * B_im
        Cc = C_re + 1j * C_im
        logdA = dt * A
        dB = dt * Bc
        l = (lambda x, dt: x.to(dt))(torch.arange(L), A_re.dtype)
        P = torch.exp(logdA[:, :, None] * l[None, None, :])
        K = torch.einsum("dn,dnl,dn->dl", Cc, P, dB).real
        L2 = 2 * L
        Kp = _pad(K, ((0, 0), (0, L)))
        up = (lambda x, *d: x.permute(*d))(u, 0, 2, 1)
        up = _pad(up, ((0, 0), (0, 0), (0, L)))
        Kf = (lambda x, axes=(-2,-1): torch.fft.rfft2(x.float(), dim=axes))(Kp[:, None, :], axes=(-2, -1))
        Uf = (lambda x, axes=(-2,-1): torch.fft.rfft2(x.float(), dim=axes))(up[:, :, None, :], axes=(-2, -1))
        Yf = Uf * Kf[None, :, :, :]
        y = (lambda x, s, axes=(-2,-1): torch.fft.irfft2(x, s=s, dim=axes).to(torch.bfloat16))(Yf, (1, L2), axes=(-2, -1))[:, :, 0, :L]
        y = (lambda x, *d: x.permute(*d))(y, 0, 2, 1) + u * Dskip[None, None, :]
        return y

    x = A_x
    g = _sigmoid((x * gate_w).sum(-1, keepdims=True))
    a = _A_ref(x, A_wqkv, A_wo)
    b = _B_ref(x, B_A_re, B_A_im, B_B_re, B_B_im, B_C_re, B_C_im, B_log_dt, B_Dskip)
    return g * a + (1 - g) * b
```

```asm
; @launch grid=(480,1,1) block=(256,1,1) lds=81920
.amdgcn_target "amdgcn-amd-amdhsa--gfx950"
.text
.globl gated_mix__mha_block__ssm_conv_s4__prompt_kernel
.p2align 8
.type gated_mix__mha_block__ssm_conv_s4__prompt_kernel,@function
gated_mix__mha_block__ssm_conv_s4__prompt_kernel:
    s_load_dwordx4 s[8:11], s[0:1], 0
    s_load_dwordx4 s[60:63], s[0:1], 112
    s_cmp_ge_u32 s2, 480
    s_cbranch_scc1 Lexit_5
    v_and_b32 v1, 63, v0
    v_lshrrev_b32 v2, 6, v0
    s_nop 0
    v_readfirstlane_b32 s3, v2
    s_cmp_lt_u32 s2, 256
    s_cbranch_scc1 LA_2
    s_setprio 3
    s_load_dwordx16 s[64:79], s[0:1], 32
    s_sub_u32 s12, s2, 256
    s_lshl_b32 s52, s12, 10
    v_lshlrev_b32 v26, 2, v0
    v_add_u32 v26, s52, v26
    s_lshr_b32 s31, s3, 1
    s_and_b32 s14, s3, 1
    s_lshl_b32 s13, s12, 1
    s_add_u32 s13, s13, s31
    s_lshl_b32 s52, s13, 1
    v_mov_b32 v27, s52
    s_bfe_u32 s54, s12, 0x10002
    s_mul_i32 s54, s54, 28
    s_lshr_b32 s55, s12, 3
    s_add_u32 s54, s54, s55
    s_and_b32 s55, s12, 3
    s_mul_i32 s55, s55, 56
    s_add_u32 s54, s54, s55
    s_mul_i32 s52, s54, 9363
    s_lshr_b32 s52, s52, 16
    s_mul_i32 s53, s52, 7
    s_sub_u32 s53, s54, s53
    s_lshl_b32 s52, s52, 1
    s_add_u32 s52, s52, s31
    s_lshl_b32 s53, s53, 1
    s_add_u32 s53, s53, s14
    s_mul_i32 s54, s52, 28672
    s_lshl_b32 s55, s53, 6
    s_add_u32 s54, s54, s55
    v_lshrrev_b32 v28, 2, v1
    v_mul_u32_u24 v28, 896, v28
    v_and_b32 v29, 3, v1
    v_lshl_add_u32 v28, v29, 4, v28
    s_add_u32 s56, s54, 13312
    s_mul_i32 s20, s3, 16896
    s_mov_b32 m0, s20
    s_mov_b32 s50, 1835008
    s_mov_b32 s51, 0x20000
    s_waitcnt lgkmcnt(0)
    s_mov_b32 s57, s54
    global_load_ushort v24, v27, s[76:77]
    global_load_dword v8, v26, s[64:65]
    global_load_dword v9, v26, s[66:67]
    global_load_dword v10, v26, s[68:69]
    global_load_dword v11, v26, s[70:71]
    global_load_dword v12, v26, s[72:73]
    global_load_dword v13, v26, s[74:75]
    global_load_ushort v25, v27, s[78:79]
    s_mov_b32 s48, s8
    s_and_b32 s49, s9, 0xffff
    buffer_load_dwordx4 v28, s[48:51], s57 offen lds
    buffer_load_dwordx4 v28, s[48:51], s56 offen offset:1024 lds
    s_setprio 1
    s_branch LS_1
LA_2:
    s_setprio 2
    s_cmp_ge_u32 s2, 72
    s_cbranch_scc1 Lnp_6
    s_getpc_b64 s[40:41]
Lpc_7:
    s_lshr_b32 s42, s2, 3
    s_lshl_b32 s42, s42, 12
    v_lshlrev_b32 v2, 4, v0
    v_add_u32 v2, s42, v2
    v_min_u32 v2, Lcode_end-Lpc_7-16, v2
    v_mov_b32 v5, s41
    v_add_co_u32 v4, vcc, s40, v2
    s_nop 1
    v_addc_co_u32 v5, vcc, 0, v5, vcc
    global_load_dwordx4 v[212:215], v[4:5], off
Lnp_6:
    s_cmp_ge_u32 s2, 224
    s_cbranch_scc1 Lgate_3
    s_and_b32 s48, s2, 7
    s_lshr_b32 s49, s2, 3
    s_and_b32 s25, s48, 3
    s_lshl_b32 s25, s25, 2
    s_and_b32 s21, s49, 3
    s_add_u32 s25, s25, s21
    s_lshr_b32 s48, s48, 2
    s_mul_i32 s48, s48, 7
    s_lshr_b32 s21, s49, 2
    s_add_u32 s21, s21, s48
    s_lshl_b32 s22, s25, 2
    s_add_u32 s22, s22, s3
    s_mul_i32 s32, s22, 28672
    s_mov_b32 s40, 0
    s_lshl_b32 s50, s3, 12
    s_add_u32 s50, s50, 49152
    s_mul_i32 s51, s3, 3072
    v_lshrrev_b32 v2, 3, v1
    v_mul_u32_u24 v3, 896, v2
    v_and_b32 v4, 7, v1
    v_lshrrev_b32 v5, 4, v1
    v_xor_b32 v6, v4, v5
    v_lshl_add_u32 v168, v6, 4, v3
    v_xor_b32 v6, 4, v6
    v_lshl_add_u32 v169, v6, 4, v3
    v_add_u32 v169, 6144, v169
    v_add_u32 v170, 12288, v168
    v_add_u32 v171, 12288, v169
    s_mul_i32 s48, s3, 43008
    s_lshl_b32 s49, s21, 7
    s_add_u32 s49, s49, s48
    v_mul_u32_u24 v3, 2688, v2
    v_and_b32 v6, 1, v5
    v_lshlrev_b32 v6, 2, v6
    v_xor_b32 v6, v4, v6
    v_lshl_add_u32 v172, v6, 4, v3
    v_add_u32 v172, s49, v172
    v_add_u32 v174, 19456, v172
    s_lshl_b32 s49, s21, 6
    s_add_u32 s49, s49, s48
    s_add_u32 s49, s49, 768
    v_lshrrev_b32 v3, 2, v1
    v_mul_u32_u24 v3, 2688, v3
    v_and_b32 v6, 3, v1
    v_lshl_add_u32 v173, v6, 4, v3
    v_add_u32 v173, s49, v173
    s_and_b32 s48, s25, 3
    s_lshl_b32 s48, s48, 1
    s_add_u32 s48, s48, s21
    s_lshr_b32 s49, s25, 2
    s_add_u32 s48, s48, s49
    s_mul_i32 s49, s48, 37
    s_lshr_b32 s49, s49, 8
    s_mul_i32 s49, s49, 7
    s_sub_u32 s48, s48, s49
    s_mov_b32 s24, s32
    s_lshl_b32 s49, s48, 7
    s_add_u32 s32, s49, s24
    s_mul_i32 s40, s48, 172032
    s_add_u32 s48, s48, 1
    s_cmp_eq_u32 s48, 7
    s_cselect_b32 s48, 0, s48
    s_lshl_b32 s49, s48, 7
    s_add_u32 s33, s49, s24
    s_mul_i32 s41, s48, 172032
    s_add_u32 s48, s48, 1
    s_cmp_eq_u32 s48, 7
    s_cselect_b32 s48, 0, s48
    s_lshl_b32 s49, s48, 7
    s_add_u32 s34, s49, s24
    s_mul_i32 s42, s48, 172032
    s_add_u32 s48, s48, 1
    s_cmp_eq_u32 s48, 7
    s_cselect_b32 s48, 0, s48
    s_lshl_b32 s49, s48, 7
    s_add_u32 s35, s49, s24
    s_mul_i32 s43, s48, 172032
    s_add_u32 s48, s48, 1
    s_cmp_eq_u32 s48, 7
    s_cselect_b32 s48, 0, s48
    s_lshl_b32 s49, s48, 7
    s_add_u32 s36, s49, s24
    s_mul_i32 s44, s48, 172032
    s_add_u32 s48, s48, 1
    s_cmp_eq_u32 s48, 7
    s_cselect_b32 s48, 0, s48
    s_lshl_b32 s49, s48, 7
    s_add_u32 s37, s49, s24
    s_mul_i32 s45, s48, 172032
    s_add_u32 s48, s48, 1
    s_cmp_eq_u32 s48, 7
    s_cselect_b32 s48, 0, s48
    s_lshl_b32 s49, s48, 7
    s_add_u32 s38, s49, s24
    s_mul_i32 s46, s48, 172032
    s_mov_b32 s14, 1835008
    s_mov_b32 s15, 0x20000
    s_mov_b32 s18, 1204224
    s_mov_b32 s19, 0x20000
    s_waitcnt lgkmcnt(0)
    s_mov_b32 s12, s8
    s_and_b32 s13, s9, 0xffff
    s_mov_b32 s16, s10
    s_and_b32 s17, s11, 0xffff
    s_add_u32 m0, s50, 0
    s_nop 0
    buffer_load_dwordx4 v168, s[12:15], s32 offen offset:0 lds
    buffer_load_dwordx4 v169, s[12:15], s32 offen offset:1024 lds
    buffer_load_dwordx4 v170, s[12:15], s32 offen offset:2048 lds
    buffer_load_dwordx4 v171, s[12:15], s32 offen offset:3072 lds
    s_add_u32 m0, s51, 0
    s_nop 0
    buffer_load_dwordx4 v172, s[16:19], s40 offen offset:0 lds
    buffer_load_dwordx4 v173, s[16:19], s40 offen offset:1024 lds
    buffer_load_dwordx4 v174, s[16:19], s40 offen offset:2048 lds
    s_add_u32 m0, s50, 16384
    s_nop 0
    buffer_load_dwordx4 v168, s[12:15], s33 offen offset:0 lds
    s_mov_b32 s4, s62
    s_and_b32 s5, s63, 0xffff
    s_mov_b32 s6, 18350080
    s_mov_b32 s7, 0x20000
    buffer_load_dwordx4 v169, s[12:15], s33 offen offset:1024 lds
    s_mov_b32 s10, s60
    s_mov_b32 s11, s61
    v_and_b32 v7, 31, v1
    v_lshrrev_b32 v8, 5, v1
    buffer_load_dwordx4 v170, s[12:15], s33 offen offset:2048 lds
    v_bfe_u32 v2, v7, 1, 3
    v_lshlrev_b32 v3, 7, v7
    v_add_u32 v3, s50, v3
    v_xor_b32 v2, v2, v8
    buffer_load_dwordx4 v171, s[12:15], s33 offen offset:3072 lds
    v_xor_b32 v4, 0, v2
    v_lshl_add_u32 v176, v4, 4, v3
    v_xor_b32 v4, 2, v2
    v_lshl_add_u32 v177, v4, 4, v3
    s_add_u32 m0, s51, 12288
    s_nop 0
    buffer_load_dwordx4 v172, s[16:19], s41 offen offset:0 lds
    v_xor_b32 v4, 4, v2
    v_lshl_add_u32 v178, v4, 4, v3
    v_xor_b32 v4, 6, v2
    v_lshl_add_u32 v179, v4, 4, v3
    buffer_load_dwordx4 v173, s[16:19], s41 offen offset:1024 lds
    v_bfe_u32 v2, v1, 2, 2
    v_bfe_u32 v3, v1, 4, 1
    v_and_b32 v4, 3, v1
    v_lshlrev_b32 v4, 3, v4
    buffer_load_dwordx4 v174, s[16:19], s41 offen offset:2048 lds
    v_lshl_add_u32 v4, v3, 5, v4
    v_lshl_add_u32 v5, v2, 7, v4
    v_lshl_add_u32 v5, v8, 11, v5
    v_lshrrev_b32 v6, 1, v2
    s_add_u32 m0, s51, 24576
    s_nop 0
    buffer_load_dwordx4 v172, s[16:19], s42 offen offset:0 lds
    v_lshl_add_u32 v180, v6, 6, v5
    v_xor_b32 v181, 64, v180
    v_lshl_add_u32 v5, v2, 6, v4
    v_lshl_add_u32 v5, v8, 9, v5
    buffer_load_dwordx4 v173, s[16:19], s42 offen offset:1024 lds
    v_add_u32 v182, 1024, v5
    v_mov_b32 v195, 0
    s_lshl_b32 s48, s21, 5
    v_add_u32 v9, s48, v7
    buffer_load_dwordx4 v174, s[16:19], s42 offen offset:2048 lds
    s_mul_i32 s55, s22, 59392
    s_add_u32 s55, s55, 2097152
    s_add_u32 m0, s51, 36864
    s_nop 0
    buffer_load_dwordx4 v172, s[16:19], s43 offen offset:0 lds
    buffer_load_dwordx4 v173, s[16:19], s43 offen offset:1024 lds
    buffer_load_dwordx4 v174, s[16:19], s43 offen offset:2048 lds
    s_waitcnt vmcnt(13)
    ds_read_b128 v[80:83], v176 offset:0
    ds_read_b128 v[84:87], v177 offset:0
    ds_read_b128 v[88:91], v178 offset:0
    ds_read_b128 v[92:95], v179 offset:0
    s_barrier
    ds_read_b64_tr_b16 v[112:113], v180 offset:0
    ds_read_b64_tr_b16 v[114:115], v180 offset:512
    ds_read_b64_tr_b16 v[116:117], v181 offset:0
    ds_read_b64_tr_b16 v[118:119], v181 offset:512
    ds_read_b64_tr_b16 v[120:121], v182 offset:0
    ds_read_b64_tr_b16 v[122:123], v182 offset:256
    ds_read_b64_tr_b16 v[124:125], v180 offset:3072
    ds_read_b64_tr_b16 v[126:127], v180 offset:3584
    ds_read_b64_tr_b16 v[128:129], v181 offset:3072
    ds_read_b64_tr_b16 v[130:131], v181 offset:3584
    ds_read_b64_tr_b16 v[132:133], v182 offset:3072
    ds_read_b64_tr_b16 v[134:135], v182 offset:3328
    s_waitcnt lgkmcnt(6)
    v_mfma_f32_32x32x16_bf16 v[16:31], v[112:115], v[80:83], 0
    ds_read_b64_tr_b16 v[136:137], v180 offset:6144
    ds_read_b64_tr_b16 v[138:139], v180 offset:6656
    s_add_u32 m0, s50, 0
    s_nop 0
    buffer_load_dwordx4 v168, s[12:15], s34 offen offset:0 lds
    buffer_load_dwordx4 v169, s[12:15], s34 offen offset:1024 lds
    v_mfma_f32_32x32x16_bf16 v[32:47], v[116:119], v[80:83], 0
    ds_read_b64_tr_b16 v[140:141], v181 offset:6144
    ds_read_b64_tr_b16 v[142:143], v181 offset:6656
    buffer_load_dwordx4 v170, s[12:15], s34 offen offset:2048 lds
    buffer_load_dwordx4 v171, s[12:15], s34 offen offset:3072 lds
    v_mfma_f32_32x32x16_bf16 v[48:63], v[80:83], v[120:123], 0
    ds_read_b64_tr_b16 v[144:145], v182 offset:6144
    ds_read_b64_tr_b16 v[146:147], v182 offset:6400
    s_waitcnt vmcnt(13)
    ds_read_b128 v[96:99], v176 offset:16384
    ds_read_b128 v[100:103], v177 offset:16384
    s_waitcnt lgkmcnt(8)
    v_mfma_f32_32x32x16_bf16 v[16:31], v[124:127], v[84:87], v[16:31]
    ds_read_b64_tr_b16 v[148:149], v180 offset:9216
    ds_read_b64_tr_b16 v[150:151], v180 offset:9728
    ds_read_b128 v[104:107], v178 offset:16384
    ds_read_b128 v[108:111], v179 offset:16384
    v_mfma_f32_32x32x16_bf16 v[32:47], v[128:131], v[84:87], v[32:47]
    ds_read_b64_tr_b16 v[152:153], v181 offset:9216
    ds_read_b64_tr_b16 v[154:155], v181 offset:9728
    v_mfma_f32_32x32x16_bf16 v[48:63], v[84:87], v[132:135], v[48:63]
    ds_read_b64_tr_b16 v[156:157], v182 offset:9216
    ds_read_b64_tr_b16 v[158:159], v182 offset:9472
    s_waitcnt lgkmcnt(4)
    s_add_u32 m0, s50, 16384
    s_nop 0
    buffer_load_dwordx4 v168, s[12:15], s35 offen offset:0 lds
    buffer_load_dwordx4 v169, s[12:15], s35 offen offset:1024 lds
    v_mfma_f32_32x32x16_bf16 v[16:31], v[136:139], v[88:91], v[16:31]
    buffer_load_dwordx4 v170, s[12:15], s35 offen offset:2048 lds
    buffer_load_dwordx4 v171, s[12:15], s35 offen offset:3072 lds
    s_waitcnt lgkmcnt(0)
    s_waitcnt vmcnt(14)
    s_barrier
    ds_read_b64_tr_b16 v[112:113], v180 offset:12288
    ds_read_b64_tr_b16 v[114:115], v180 offset:12800
    v_mfma_f32_32x32x16_bf16 v[32:47], v[140:143], v[88:91], v[32:47]
    ds_read_b64_tr_b16 v[116:117], v181 offset:12288
    ds_read_b64_tr_b16 v[118:119], v181 offset:12800
    s_add_u32 m0, s51, 0
    s_nop 0
    buffer_load_dwordx4 v172, s[16:19], s44 offen offset:0 lds
    v_mfma_f32_32x32x16_bf16 v[48:63], v[88:91], v[144:147], v[48:63]
    ds_read_b64_tr_b16 v[120:121], v182 offset:12288
    ds_read_b64_tr_b16 v[122:123], v182 offset:12544
    global_load_dwordx2 v[204:205], v195, s[10:11] sc1
    v_mfma_f32_32x32x16_bf16 v[16:31], v[148:151], v[92:95], v[16:31]
    ds_read_b64_tr_b16 v[124:125], v180 offset:15360
    ds_read_b64_tr_b16 v[126:127], v180 offset:15872
    buffer_load_dwordx4 v173, s[16:19], s44 offen offset:1024 lds
    v_mfma_f32_32x32x16_bf16 v[32:47], v[152:155], v[92:95], v[32:47]
    ds_read_b64_tr_b16 v[128:129], v181 offset:15360
    ds_read_b64_tr_b16 v[130:131], v181 offset:15872
    v_mfma_f32_32x32x16_bf16 v[48:63], v[92:95], v[156:159], v[48:63]
    ds_read_b64_tr_b16 v[132:133], v182 offset:15360
    ds_read_b64_tr_b16 v[134:135], v182 offset:15616
    buffer_load_dwordx4 v174, s[16:19], s44 offen offset:2048 lds
    s_waitcnt lgkmcnt(6)
    v_mfma_f32_32x32x16_bf16 v[16:31], v[112:115], v[96:99], v[16:31]
    ds_read_b64_tr_b16 v[136:137], v180 offset:18432
    ds_read_b64_tr_b16 v[138:139], v180 offset:18944
    s_waitcnt vmcnt(8)
    ds_read_b128 v[80:83], v176 offset:0
    ds_read_b128 v[84:87], v177 offset:0
    v_mfma_f32_32x32x16_bf16 v[32:47], v[116:119], v[96:99], v[32:47]
    ds_read_b64_tr_b16 v[140:141], v181 offset:18432
    ds_read_b64_tr_b16 v[142:143], v181 offset:18944
    ds_read_b128 v[88:91], v178 offset:0
    ds_read_b128 v[92:95], v179 offset:0
    v_mfma_f32_32x32x16_bf16 v[48:63], v[96:99], v[120:123], v[48:63]
    ds_read_b64_tr_b16 v[144:145], v182 offset:18432
    ds_read_b64_tr_b16 v[146:147], v182 offset:18688
    s_waitcnt lgkmcnt(10)
    v_mfma_f32_32x32x16_bf16 v[16:31], v[124:127], v[100:103], v[16:31]
    ds_read_b64_tr_b16 v[148:149], v180 offset:21504
    ds_read_b64_tr_b16 v[150:151], v180 offset:22016
    s_waitcnt lgkmcnt(4)
    s_add_u32 m0, s50, 0
    s_nop 0
    buffer_load_dwordx4 v168, s[12:15], s36 offen offset:0 lds
    v_mfma_f32_32x32x16_bf16 v[32:47], v[128:131], v[100:103], v[32:47]
    ds_read_b64_tr_b16 v[152:153], v181 offset:21504
    ds_read_b64_tr_b16 v[154:155], v181 offset:22016
    buffer_load_dwordx4 v169, s[12:15], s36 offen offset:1024 lds
    v_mfma_f32_32x32x16_bf16 v[48:63], v[100:103], v[132:135], v[48:63]
    ds_read_b64_tr_b16 v[156:157], v182 offset:21504
    ds_read_b64_tr_b16 v[158:159], v182 offset:21760
    buffer_load_dwordx4 v170, s[12:15], s36 offen offset:2048 lds
    s_waitcnt lgkmcnt(6)
    v_mfma_f32_32x32x16_bf16 v[16:31], v[136:139], v[104:107], v[16:31]
    buffer_load_dwordx4 v171, s[12:15], s36 offen offset:3072 lds
    s_waitcnt lgkmcnt(0)
    s_barrier
    ds_read_b64_tr_b16 v[112:113], v180 offset:24576
    ds_read_b64_tr_b16 v[114:115], v180 offset:25088
    v_mfma_f32_32x32x16_bf16 v[32:47], v[140:143], v[104:107], v[32:47]
    ds_read_b64_tr_b16 v[116:117], v181 offset:24576
    ds_read_b64_tr_b16 v[118:119], v181 offset:25088
    s_add_u32 m0, s51, 12288
    s_nop 0
    buffer_load_dwordx4 v172, s[16:19], s45 offen offset:0 lds
    v_mfma_f32_32x32x16_bf16 v[48:63], v[104:107], v[144:147], v[48:63]
    ds_read_b64_tr_b16 v[120:121], v182 offset:24576
    ds_read_b64_tr_b16 v[122:123], v182 offset:24832
    v_mfma_f32_32x32x16_bf16 v[16:31], v[148:151], v[108:111], v[16:31]
    ds_read_b64_tr_b16 v[124:125], v180 offset:27648
    ds_read_b64_tr_b16 v[126:127], v180 offset:28160
    buffer_load_dwordx4 v173, s[16:19], s45 offen offset:1024 lds
    v_mfma_f32_32x32x16_bf16 v[32:47], v[152:155], v[108:111], v[32:47]
    ds_read_b64_tr_b16 v[128:129], v181 offset:27648
    ds_read_b64_tr_b16 v[130:131], v181 offset:28160
    v_mfma_f32_32x32x16_bf16 v[48:63], v[108:111], v[156:159], v[48:63]
    ds_read_b64_tr_b16 v[132:133], v182 offset:27648
    ds_read_b64_tr_b16 v[134:135], v182 offset:27904
    buffer_load_dwordx4 v174, s[16:19], s45 offen offset:2048 lds
    s_waitcnt lgkmcnt(6)
    v_mfma_f32_32x32x16_bf16 v[16:31], v[112:115], v[80:83], v[16:31]
    ds_read_b64_tr_b16 v[136:137], v180 offset:30720
    ds_read_b64_tr_b16 v[138:139], v180 offset:31232
    s_waitcnt vmcnt(11)
    ds_read_b128 v[96:99], v176 offset:16384
    ds_read_b128 v[100:103], v177 offset:16384
    v_mfma_f32_32x32x16_bf16 v[32:47], v[116:119], v[80:83], v[32:47]
    ds_read_b64_tr_b16 v[140:141], v181 offset:30720
    ds_read_b64_tr_b16 v[142:143], v181 offset:31232
    ds_read_b128 v[104:107], v178 offset:16384
    ds_read_b128 v[108:111], v179 offset:16384
    v_mfma_f32_32x32x16_bf16 v[48:63], v[80:83], v[120:123], v[48:63]
    ds_read_b64_tr_b16 v[144:145], v182 offset:30720
    ds_read_b64_tr_b16 v[146:147], v182 offset:30976
    s_waitcnt lgkmcnt(10)
    v_mfma_f32_32x32x16_bf16 v[16:31], v[124:127], v[84:87], v[16:31]
    ds_read_b64_tr_b16 v[148:149], v180 offset:33792
    ds_read_b64_tr_b16 v[150:151], v180 offset:34304
    s_waitcnt lgkmcnt(4)
    s_add_u32 m0, s50, 16384
    s_nop 0
    buffer_load_dwordx4 v168, s[12:15], s37 offen offset:0 lds
    v_mfma_f32_32x32x16_bf16 v[32:47], v[128:131], v[84:87], v[32:47]
    ds_read_b64_tr_b16 v[152:153], v181 offset:33792
    ds_read_b64_tr_b16 v[154:155], v181 offset:34304
    buffer_load_dwordx4 v169, s[12:15], s37 offen offset:1024 lds
    v_mfma_f32_32x32x16_bf16 v[48:63], v[84:87], v[132:135], v[48:63]
    ds_read_b64_tr_b16 v[156:157], v182 offset:33792
    ds_read_b64_tr_b16 v[158:159], v182 offset:34048
    buffer_load_dwordx4 v170, s[12:15], s37 offen offset:2048 lds
    s_waitcnt lgkmcnt(6)
    v_mfma_f32_32x32x16_bf16 v[16:31], v[136:139], v[88:91], v[16:31]
    buffer_load_dwordx4 v171, s[12:15], s37 offen offset:3072 lds
    s_waitcnt lgkmcnt(0)
    s_barrier
    ds_read_b64_tr_b16 v[112:113], v180 offset:36864
    ds_read_b64_tr_b16 v[114:115], v180 offset:37376
    v_mfma_f32_32x32x16_bf16 v[32:47], v[140:143], v[88:91], v[32:47]
    ds_read_b64_tr_b16 v[116:117], v181 offset:36864
    ds_read_b64_tr_b16 v[118:119], v181 offset:37376
    s_add_u32 m0, s51, 24576
    s_nop 0
    buffer_load_dwordx4 v172, s[16:19], s46 offen offset:0 lds
    v_mfma_f32_32x32x16_bf16 v[48:63], v[88:91], v[144:147], v[48:63]
    ds_read_b64_tr_b16 v[120:121], v182 offset:36864
    ds_read_b64_tr_b16 v[122:123], v182 offset:37120
    v_mfma_f32_32x32x16_bf16 v[16:31], v[148:151], v[92:95], v[16:31]
    ds_read_b64_tr_b16 v[124:125], v180 offset:39936
    ds_read_b64_tr_b16 v[126:127], v180 offset:40448
    buffer_load_dwordx4 v173, s[16:19], s46 offen offset:1024 lds
    v_mfma_f32_32x32x16_bf16 v[32:47], v[152:155], v[92:95], v[32:47]
    ds_read_b64_tr_b16 v[128:129], v181 offset:39936
    ds_read_b64_tr_b16 v[130:131], v181 offset:40448
    v_mfma_f32_32x32x16_bf16 v[48:63], v[92:95], v[156:159], v[48:63]
    ds_read_b64_tr_b16 v[132:133], v182 offset:39936
    ds_read_b64_tr_b16 v[134:135], v182 offset:40192
    buffer_load_dwordx4 v174, s[16:19], s46 offen offset:2048 lds
    s_waitcnt lgkmcnt(6)
    v_mfma_f32_32x32x16_bf16 v[16:31], v[112:115], v[96:99], v[16:31]
    ds_read_b64_tr_b16 v[136:137], v180 offset:43008
    ds_read_b64_tr_b16 v[138:139], v180 offset:43520
    s_waitcnt vmcnt(10)
    ds_read_b128 v[80:83], v176 offset:0
    ds_read_b128 v[84:87], v177 offset:0
    v_mfma_f32_32x32x16_bf16 v[32:47], v[116:119], v[96:99], v[32:47]
    ds_read_b64_tr_b16 v[140:141], v181 offset:43008
    ds_read_b64_tr_b16 v[142:143], v181 offset:43520
    ds_read_b128 v[88:91], v178 offset:0
    ds_read_b128 v[92:95], v179 offset:0
    v_mfma_f32_32x32x16_bf16 v[48:63], v[96:99], v[120:123], v[48:63]
    ds_read_b64_tr_b16 v[144:145], v182 offset:43008
    ds_read_b64_tr_b16 v[146:147], v182 offset:43264
    s_waitcnt lgkmcnt(10)
    v_mfma_f32_32x32x16_bf16 v[16:31], v[124:127], v[100:103], v[16:31]
    ds_read_b64_tr_b16 v[148:149], v180 offset:46080
    ds_read_b64_tr_b16 v[150:151], v180 offset:46592
    s_waitcnt lgkmcnt(4)
    s_add_u32 m0, s50, 0
    s_nop 0
    buffer_load_dwordx4 v168, s[12:15], s38 offen offset:0 lds
    v_mfma_f32_32x32x16_bf16 v[32:47], v[128:131], v[100:103], v[32:47]
    ds_read_b64_tr_b16 v[152:153], v181 offset:46080
    ds_read_b64_tr_b16 v[154:155], v181 offset:46592
    buffer_load_dwordx4 v169, s[12:15], s38 offen offset:1024 lds
    v_mfma_f32_32x32x16_bf16 v[48:63], v[100:103], v[132:135], v[48:63]
    ds_read_b64_tr_b16 v[156:157], v182 offset:46080
    ds_read_b64_tr_b16 v[158:159], v182 offset:46336
    buffer_load_dwordx4 v170, s[12:15], s38 offen offset:2048 lds
    s_waitcnt lgkmcnt(6)
    v_mfma_f32_32x32x16_bf16 v[16:31], v[136:139], v[104:107], v[16:31]
    buffer_load_dwordx4 v171, s[12:15], s38 offen offset:3072 lds
    s_waitcnt lgkmcnt(0)
    s_barrier
    ds_read_b64_tr_b16 v[112:113], v180 offset:0
    ds_read_b64_tr_b16 v[114:115], v180 offset:512
    v_mfma_f32_32x32x16_bf16 v[32:47], v[140:143], v[104:107], v[32:47]
    ds_read_b64_tr_b16 v[116:117], v181 offset:0
    ds_read_b64_tr_b16 v[118:119], v181 offset:512
    v_mfma_f32_32x32x16_bf16 v[48:63], v[104:107], v[144:147], v[48:63]
    ds_read_b64_tr_b16 v[120:121], v182 offset:0
    ds_read_b64_tr_b16 v[122:123], v182 offset:256
    v_mfma_f32_32x32x16_bf16 v[16:31], v[148:151], v[108:111], v[16:31]
    ds_read_b64_tr_b16 v[124:125], v180 offset:3072
    ds_read_b64_tr_b16 v[126:127], v180 offset:3584
    v_mfma_f32_32x32x16_bf16 v[32:47], v[152:155], v[108:111], v[32:47]
    ds_read_b64_tr_b16 v[128:129], v181 offset:3072
    ds_read_b64_tr_b16 v[130:131], v181 offset:3584
    v_mfma_f32_32x32x16_bf16 v[48:63], v[108:111], v[156:159], v[48:63]
    ds_read_b64_tr_b16 v[132:133], v182 offset:3072
    ds_read_b64_tr_b16 v[134:135], v182 offset:3328
    s_waitcnt lgkmcnt(6)
    v_mfma_f32_32x32x16_bf16 v[16:31], v[112:115], v[80:83], v[16:31]
    ds_read_b64_tr_b16 v[136:137], v180 offset:6144
    ds_read_b64_tr_b16 v[138:139], v180 offset:6656
    s_waitcnt vmcnt(7)
    ds_read_b128 v[96:99], v176 offset:16384
    ds_read_b128 v[100:103], v177 offset:16384
    s_mul_i32 s56, s22, 28672
    s_add_u32 s56, s56, 0
    s_sub_u32 s57, s55, 28672
    v_mfma_f32_32x32x16_bf16 v[32:47], v[116:119], v[80:83], v[32:47]
    ds_read_b64_tr_b16 v[140:141], v181 offset:6144
    ds_read_b64_tr_b16 v[142:143], v181 offset:6656
    ds_read_b128 v[104:107], v178 offset:16384
    ds_read_b128 v[108:111], v179 offset:16384
    s_cmp_lt_u32 s21, 7
    s_cselect_b32 s52, 0x3e8b97f6, 1.0
    s_cselect_b32 s54, s56, s57
    v_mfma_f32_32x32x16_bf16 v[48:63], v[80:83], v[120:123], v[48:63]
    ds_read_b64_tr_b16 v[144:145], v182 offset:6144
    ds_read_b64_tr_b16 v[146:147], v182 offset:6400
    s_lshl_b32 s56, s21, 12
    s_add_u32 s54, s54, s56
    v_lshlrev_b32 v184, 4, v1
    s_waitcnt lgkmcnt(10)
    v_mfma_f32_32x32x16_bf16 v[16:31], v[124:127], v[84:87], v[16:31]
    ds_read_b64_tr_b16 v[148:149], v180 offset:9216
    ds_read_b64_tr_b16 v[150:151], v180 offset:9728
    v_mul_u32_u24 v3, 7168, v8
    v_lshl_add_u32 v192, v9, 4, v3
    s_lshl_b32 s56, s21, 7
    v_mfma_f32_32x32x16_bf16 v[32:47], v[128:131], v[84:87], v[32:47]
    ds_read_b64_tr_b16 v[152:153], v181 offset:9216
    ds_read_b64_tr_b16 v[154:155], v181 offset:9728
    s_add_u32 s56, s56, s55
    s_add_u32 s58, s56, 57344
    s_add_u32 s55, s55, 28672
    v_mfma_f32_32x32x16_bf16 v[48:63], v[84:87], v[132:135], v[48:63]
    ds_read_b64_tr_b16 v[156:157], v182 offset:9216
    ds_read_b64_tr_b16 v[158:159], v182 offset:9472
    s_add_u32 s59, s55, 14336
    v_mov_b32 v12, 0x3f803f80
    v_mov_b32 v13, 0x3f803f80
    s_waitcnt lgkmcnt(6)
    v_mfma_f32_32x32x16_bf16 v[16:31], v[136:139], v[88:91], v[16:31]
    s_waitcnt lgkmcnt(0)
    s_barrier
    ds_read_b64_tr_b16 v[112:113], v180 offset:12288
    ds_read_b64_tr_b16 v[114:115], v180 offset:12800
    v_mov_b32 v14, 0x3f803f80
    v_mov_b32 v15, 0x3f803f80
    s_lshl_b32 s56, s21, 4
    v_mfma_f32_32x32x16_bf16 v[32:47], v[140:143], v[88:91], v[32:47]
    ds_read_b64_tr_b16 v[116:117], v181 offset:12288
    ds_read_b64_tr_b16 v[118:119], v181 offset:12800
    s_add_u32 s56, s56, s25
    s_mul_i32 s56, s56, 128
    v_lshlrev_b32 v211, 3, v1
    v_mfma_f32_32x32x16_bf16 v[48:63], v[88:91], v[144:147], v[48:63]
    ds_read_b64_tr_b16 v[120:121], v182 offset:12288
    ds_read_b64_tr_b16 v[122:123], v182 offset:12544
    v_add_u32 v211, s56, v211
    s_mov_b64 s[26:27], 0xffff
    v_mfma_f32_32x32x16_bf16 v[16:31], v[148:151], v[92:95], v[16:31]
    ds_read_b64_tr_b16 v[124:125], v180 offset:15360
    ds_read_b64_tr_b16 v[126:127], v180 offset:15872
    v_mfma_f32_32x32x16_bf16 v[32:47], v[152:155], v[92:95], v[32:47]
    ds_read_b64_tr_b16 v[128:129], v181 offset:15360
    ds_read_b64_tr_b16 v[130:131], v181 offset:15872
    v_mfma_f32_32x32x16_bf16 v[48:63], v[92:95], v[156:159], v[48:63]
    ds_read_b64_tr_b16 v[132:133], v182 offset:15360
    ds_read_b64_tr_b16 v[134:135], v182 offset:15616
    s_waitcnt lgkmcnt(6)
    v_mfma_f32_32x32x16_bf16 v[16:31], v[112:115], v[96:99], v[16:31]
    ds_read_b64_tr_b16 v[136:137], v180 offset:18432
    ds_read_b64_tr_b16 v[138:139], v180 offset:18944
    s_waitcnt vmcnt(0)
    ds_read_b128 v[80:83], v176 offset:0
    ds_read_b128 v[84:87], v177 offset:0
    v_mfma_f32_32x32x16_bf16 v[32:47], v[116:119], v[96:99], v[32:47]
    ds_read_b64_tr_b16 v[140:141], v181 offset:18432
    ds_read_b64_tr_b16 v[142:143], v181 offset:18944
    ds_read_b128 v[88:91], v178 offset:0
    ds_read_b128 v[92:95], v179 offset:0
    v_mfma_f32_32x32x16_bf16 v[48:63], v[96:99], v[120:123], v[48:63]
    ds_read_b64_tr_b16 v[144:145], v182 offset:18432
    ds_read_b64_tr_b16 v[146:147], v182 offset:18688
    s_waitcnt lgkmcnt(10)
    v_mfma_f32_32x32x16_bf16 v[16:31], v[124:127], v[100:103], v[16:31]
    ds_read_b64_tr_b16 v[148:149], v180 offset:21504
    ds_read_b64_tr_b16 v[150:151], v180 offset:22016
    v_mfma_f32_32x32x16_bf16 v[32:47], v[128:131], v[100:103], v[32:47]
    ds_read_b64_tr_b16 v[152:153], v181 offset:21504
    ds_read_b64_tr_b16 v[154:155], v181 offset:22016
    v_mfma_f32_32x32x16_bf16 v[48:63], v[100:103], v[132:135], v[48:63]
    ds_read_b64_tr_b16 v[156:157], v182 offset:21504
    ds_read_b64_tr_b16 v[158:159], v182 offset:21760
    s_waitcnt lgkmcnt(6)
    v_mfma_f32_32x32x16_bf16 v[16:31], v[136:139], v[104:107], v[16:31]
    s_waitcnt lgkmcnt(0)
    s_barrier
    s_mov_b32 s48, 2097152
Ltag_8:
    v_readfirstlane_b32 s8, v204
    v_readfirstlane_b32 s9, v205
    s_nop 0
    s_cmp_lg_u32 s8, 0
    s_cbranch_scc1 Ltagd_9
    s_sub_u32 s48, s48, 1
    s_cbranch_scc1 Ltagd_9
    global_load_dwordx2 v[204:205], v195, s[10:11] sc1
    s_waitcnt vmcnt(0)
    s_branch Ltag_8
Ltagd_9:
    s_getreg_b32 s48, hwreg(HW_REG_XCC_ID, 0, 3)
    s_getreg_b32 s49, hwreg(HW_REG_HW_ID, 8, 8)
    s_lshl_b32 s48, s48, 8
    s_or_b32 s48, s48, s49
    s_lshl_b32 s48, s48, 7
    s_add_u32 s48, s48, 18087936
    s_mov_b64 exec, 1
    buffer_store_dwordx2 v[204:205], v195, s[4:7], s48 offen
    s_mov_b64 exec, -1
    ds_read_b64_tr_b16 v[112:113], v180 offset:24576
    ds_read_b64_tr_b16 v[114:115], v180 offset:25088
    v_mfma_f32_32x32x16_bf16 v[32:47], v[140:143], v[104:107], v[32:47]
    ds_read_b64_tr_b16 v[116:117], v181 offset:24576
    ds_read_b64_tr_b16 v[118:119], v181 offset:25088
    v_mfma_f32_32x32x16_bf16 v[48:63], v[104:107], v[144:147], v[48:63]
    ds_read_b64_tr_b16 v[120:121], v182 offset:24576
    ds_read_b64_tr_b16 v[122:123], v182 offset:24832
    v_mfma_f32_32x32x16_bf16 v[16:31], v[148:151], v[108:111], v[16:31]
    ds_read_b64_tr_b16 v[124:125], v180 offset:27648
    ds_read_b64_tr_b16 v[126:127], v180 offset:28160
    v_mfma_f32_32x32x16_bf16 v[32:47], v[152:155], v[108:111], v[32:47]
    ds_read_b64_tr_b16 v[128:129], v181 offset:27648
    ds_read_b64_tr_b16 v[130:131], v181 offset:28160
    v_mfma_f32_32x32x16_bf16 v[48:63], v[108:111], v[156:159], v[48:63]
    ds_read_b64_tr_b16 v[132:133], v182 offset:27648
    ds_read_b64_tr_b16 v[134:135], v182 offset:27904
    s_waitcnt lgkmcnt(6)
    v_mfma_f32_32x32x16_bf16 v[16:31], v[112:115], v[80:83], v[16:31]
    ds_read_b64_tr_b16 v[136:137], v180 offset:30720
    ds_read_b64_tr_b16 v[138:139], v180 offset:31232
    v_mfma_f32_32x32x16_bf16 v[32:47], v[116:119], v[80:83], v[32:47]
    ds_read_b64_tr_b16 v[140:141], v181 offset:30720
    ds_read_b64_tr_b16 v[142:143], v181 offset:31232
    v_mfma_f32_32x32x16_bf16 v[48:63], v[80:83], v[120:123], v[48:63]
    ds_read_b64_tr_b16 v[144:145], v182 offset:30720
    ds_read_b64_tr_b16 v[146:147], v182 offset:30976
    s_waitcnt lgkmcnt(6)
    v_mfma_f32_32x32x16_bf16 v[16:31], v[124:127], v[84:87], v[16:31]
    ds_read_b64_tr_b16 v[148:149], v180 offset:33792
    ds_read_b64_tr_b16 v[150:151], v180 offset:34304
    v_mfma_f32_32x32x16_bf16 v[32:47], v[128:131], v[84:87], v[32:47]
    ds_read_b64_tr_b16 v[152:153], v181 offset:33792
    ds_read_b64_tr_b16 v[154:155], v181 offset:34304
    v_mfma_f32_32x32x16_bf16 v[48:63], v[84:87], v[132:135], v[48:63]
    ds_read_b64_tr_b16 v[156:157], v182 offset:33792
    ds_read_b64_tr_b16 v[158:159], v182 offset:34048
    s_waitcnt lgkmcnt(6)
    v_mfma_f32_32x32x16_bf16 v[16:31], v[136:139], v[88:91], v[16:31]
    v_mfma_f32_32x32x16_bf16 v[32:47], v[140:143], v[88:91], v[32:47]
    v_mfma_f32_32x32x16_bf16 v[48:63], v[88:91], v[144:147], v[48:63]
    s_waitcnt lgkmcnt(0)
    v_mfma_f32_32x32x16_bf16 v[16:31], v[148:151], v[92:95], v[16:31]
    v_mfma_f32_32x32x16_bf16 v[32:47], v[152:155], v[92:95], v[32:47]
    v_mfma_f32_32x32x16_bf16 v[48:63], v[92:95], v[156:159], v[48:63]
    s_mov_b64 exec, 0xff
    buffer_store_dwordx4 v[12:15], v184, s[4:7], s58 offen sc1
    s_mov_b64 exec, -1
    s_nop 6
    v_mul_f32 v16, s52, v16
    v_mul_f32 v17, s52, v17
    v_mul_f32 v18, s52, v18
    v_mul_f32 v19, s52, v19
    v_mul_f32 v20, s52, v20
    v_mul_f32 v21, s52, v21
    v_mul_f32 v22, s52, v22
    v_mul_f32 v23, s52, v23
    v_mul_f32 v24, s52, v24
    v_mul_f32 v25, s52, v25
    v_mul_f32 v26, s52, v26
    v_mul_f32 v27, s52, v27
    v_mul_f32 v28, s52, v28
    v_mul_f32 v29, s52, v29
    v_mul_f32 v30, s52, v30
    v_mul_f32 v31, s52, v31
    v_cvt_pk_bf16_f32 v96, v16, v17
    v_cvt_pk_bf16_f32 v97, v18, v19
    v_cvt_pk_bf16_f32 v98, v20, v21
    v_cvt_pk_bf16_f32 v99, v22, v23
    v_cvt_pk_bf16_f32 v100, v24, v25
    v_cvt_pk_bf16_f32 v101, v26, v27
    v_cvt_pk_bf16_f32 v102, v28, v29
    v_cvt_pk_bf16_f32 v103, v30, v31
    v_permlane32_swap_b32 v96, v98
    v_permlane32_swap_b32 v97, v99
    v_permlane32_swap_b32 v100, v102
    v_permlane32_swap_b32 v101, v103
    buffer_store_dwordx4 v[96:99], v184, s[4:7], s54 offen offset:0 sc1
    buffer_store_dwordx4 v[100:103], v184, s[4:7], s54 offen offset:1024 sc1
    v_mul_f32 v32, s52, v32
    v_mul_f32 v33, s52, v33
    v_mul_f32 v34, s52, v34
    v_mul_f32 v35, s52, v35
    v_mul_f32 v36, s52, v36
    v_mul_f32 v37, s52, v37
    v_mul_f32 v38, s52, v38
    v_mul_f32 v39, s52, v39
    v_mul_f32 v40, s52, v40
    v_mul_f32 v41, s52, v41
    v_mul_f32 v42, s52, v42
    v_mul_f32 v43, s52, v43
    v_mul_f32 v44, s52, v44
    v_mul_f32 v45, s52, v45
    v_mul_f32 v46, s52, v46
    v_mul_f32 v47, s52, v47
    v_cvt_pk_bf16_f32 v104, v32, v33
    v_cvt_pk_bf16_f32 v105, v34, v35
    v_cvt_pk_bf16_f32 v106, v36, v37
    v_cvt_pk_bf16_f32 v107, v38, v39
    v_cvt_pk_bf16_f32 v108, v40, v41
    v_cvt_pk_bf16_f32 v109, v42, v43
    v_cvt_pk_bf16_f32 v110, v44, v45
    v_cvt_pk_bf16_f32 v111, v46, v47
    v_permlane32_swap_b32 v104, v106
    v_permlane32_swap_b32 v105, v107
    v_permlane32_swap_b32 v108, v110
    v_permlane32_swap_b32 v109, v111
    buffer_store_dwordx4 v[104:107], v184, s[4:7], s54 offen offset:2048 sc1
    buffer_store_dwordx4 v[108:111], v184, s[4:7], s54 offen offset:3072 sc1
    v_cvt_pk_bf16_f32 v80, v48, v49
    v_cvt_pk_bf16_f32 v81, v50, v51
    v_cvt_pk_bf16_f32 v82, v52, v53
    v_cvt_pk_bf16_f32 v83, v54, v55
    v_cvt_pk_bf16_f32 v84, v56, v57
    v_cvt_pk_bf16_f32 v85, v58, v59
    v_cvt_pk_bf16_f32 v86, v60, v61
    v_cvt_pk_bf16_f32 v87, v62, v63
    buffer_store_dwordx4 v[80:83], v192, s[4:7], s55 offen sc1
    buffer_store_dwordx4 v[84:87], v192, s[4:7], s59 offen sc1
Lattn_4:
    v_lshlrev_b32 v2, 4, v1
    v_mov_b32 v12, 0
    s_and_b32 s21, s2, 7
    s_lshl_b32 s21, s21, 1
    s_bfe_u32 s23, s2, 0x10003
    s_add_u32 s21, s21, s23
    s_lshr_b32 s22, s2, 4
    s_mov_b32 s25, 2097152
    s_mul_i32 s23, s3, 950272
    s_add_u32 s32, s25, s23
    s_add_u32 s33, s32, 59392
    s_add_u32 s34, s32, 118784
    s_add_u32 s35, s32, 178176
    s_add_u32 s36, s32, 237568
    s_add_u32 s37, s32, 296960
    s_add_u32 s38, s32, 356352
    s_add_u32 s39, s32, 415744
    s_add_u32 s40, s32, 475136
    s_add_u32 s41, s32, 534528
    s_add_u32 s42, s32, 593920
    s_add_u32 s43, s32, 653312
    s_add_u32 s44, s32, 712704
    s_add_u32 s45, s32, 772096
    s_add_u32 s46, s32, 831488
    s_add_u32 s47, s32, 890880
    s_mul_i32 s23, s22, 114688
    s_add_u32 s24, s3, 0
    s_and_b32 s24, s24, 3
    s_mul_i32 s56, s24, 12288
    s_mul_i32 s24, s24, 28672
    s_add_u32 s48, s23, s24
    s_add_u32 s24, s3, 1
    s_and_b32 s24, s24, 3
    s_mul_i32 s57, s24, 12288
    s_mul_i32 s24, s24, 28672
    s_add_u32 s49, s23, s24
    s_add_u32 s24, s3, 2
    s_and_b32 s24, s24, 3
    s_mul_i32 s58, s24, 12288
    s_mul_i32 s24, s24, 28672
    s_add_u32 s50, s23, s24
    s_add_u32 s24, s3, 3
    s_and_b32 s24, s24, 3
    s_mul_i32 s59, s24, 12288
    s_mul_i32 s24, s24, 28672
    s_add_u32 s51, s23, s24
    s_mul_i32 s23, s21, 7
    s_lshr_b32 s23, s23, 1
    s_lshl_b32 s23, s23, 9
    v_add_u32 v3, s23, v2
    s_mul_i32 s23, s21, 448
    s_lshr_b32 s24, s23, 9
    s_lshl_b32 s24, s24, 7
    s_add_u32 s24, s24, 57344
    s_add_u32 s23, s23, 28672
    v_bfe_u32 v4, v1, 4, 1
    v_bfe_u32 v5, v1, 2, 1
    v_lshl_add_u32 v4, v4, 1, v5
    v_mul_u32_u24 v4, 7, v4
    v_bfe_u32 v5, v1, 3, 1
    v_and_b32 v6, 3, v1
    v_lshl_add_u32 v6, v5, 2, v6
    v_add_u32 v4, v4, v6
    v_cmp_gt_u32 vcc, 7, v6
    v_lshrrev_b32 v5, 5, v1
    v_mul_u32_u24 v5, 7168, v5
    v_lshl_add_u32 v5, v4, 4, v5
    v_add_u32 v5, s23, v5
    v_add_u32 v6, 14336, v5
    v_mov_b32 v7, s24
    v_cndmask_b32 v208, v7, v5, vcc
    v_cndmask_b32 v216, v7, v6, vcc
    v_and_b32 v4, 3, v1
    v_mul_u32_u24 v4, 0x3c6ef2, v4
    v_add_u32 v4, 0x9e3779b1, v4
    s_xor_b32 s23, s8, s9
    v_mul_lo_u32 v4, s23, v4
    v_and_b32 v4, 0x9fff0000, v4
    v_or_b32 v217, 0x20000000, v4
    v_lshlrev_b32 v218, 3, v1
    s_and_b32 s23, s21, 1
    s_sub_u32 s23, s23, 1
    s_not_b32 s24, s23
    v_mov_b32 v4, s23
    v_mov_b32 v5, s24
    v_cmp_gt_u32 vcc, 32, v1
    s_nop 1
    v_cndmask_b32 v209, -1, v4, vcc
    v_cndmask_b32 v210, v5, -1, vcc
    v_lshrrev_b32 v4, 2, v1
    v_and_b32 v5, 1, v4
    v_mul_u32_u24 v5, 27, v5
    s_mul_i32 s23, s21, 28
    v_add_u32 v5, s23, v5
    v_lshrrev_b32 v4, 1, v4
    v_lshrrev_b32 v6, 6, v5
    v_lshrrev_b32 v7, 5, v5
    v_cmp_eq_u32 vcc, 1, v4
    s_nop 1
    v_cndmask_b32 v6, v6, v7, vcc
    v_add_u32 v7, 7, v6
    v_cmp_eq_u32 vcc, 0, v4
    s_nop 1
    v_cndmask_b32 v6, v6, v7, vcc
    v_and_b32 v7, 3, v1
    s_lshl_b32 s23, s3, 2
    v_add_u32 v7, s23, v7
    v_mov_b32 v8, s22
    v_cmp_eq_u32 vcc, 2, v4
    s_nop 1
    v_cndmask_b32 v7, v7, v8, vcc
    v_lshl_add_u32 v6, v6, 4, v7
    v_mul_u32_u24 v13, 128, v6
    s_lshl_b32 s28, s22, 2
    s_add_u32 s28, s28, s3
    s_lshl_b32 s29, s28, 4
    s_add_u32 s29, s29, s21
    s_lshl_b32 s28, s29, 11
    s_add_u32 s28, s28, 13631488
    s_mul_i32 s29, s29, 128
    s_add_u32 s29, s29, 17891328
    v_add_u32 v4, s56, v2
    v_add_u32 v5, s57, v2
    v_add_u32 v6, s58, v2
    v_add_u32 v7, s59, v2
    v_mov_b32 v14, s8
    v_mov_b32 v15, s9
    s_mov_b32 s23, 17825792
    s_waitcnt vmcnt(0)
    s_barrier
    s_cmp_lg_u32 s3, 0
    s_cbranch_scc1 Lnf_10
    s_mov_b64 exec, s[26:27]
    buffer_store_dwordx2 v[14:15], v211, s[4:7], s23 offen sc1
    s_mov_b64 exec, -1
Lnf_10:
    s_mov_b64 exec, 0x11ffff
    s_mov_b32 s24, 2097152
Lpoll_11:
    buffer_load_dwordx2 v[8:9], v13, s[4:7], s23 offen sc1
    s_waitcnt vmcnt(0)
    v_cmp_ne_u64 vcc, s[8:9], v[8:9]
    s_nop 1
    s_and_b64 exec, exec, vcc
    s_cbranch_scc0 Lpolld_12
    s_sub_u32 s24, s24, 1
    s_cbranch_scc1 Lpolld_12
    s_sleep 1
    s_branch Lpoll_11
Lpolld_12:
    s_mov_b64 exec, -1
    buffer_load_dwordx4 v[160:163], v3, s[4:7], s32 offen offset:0
    buffer_load_dwordx4 v[164:167], v3, s[4:7], s32 offen offset:1024
    buffer_load_dwordx4 v[16:19], v3, s[4:7], s48 offen offset:0
    buffer_load_dwordx4 v[20:23], v3, s[4:7], s48 offen offset:1024
    buffer_load_dwordx4 v[24:27], v3, s[4:7], s49 offen offset:0
    buffer_load_dwordx4 v[28:31], v3, s[4:7], s49 offen offset:1024
    buffer_load_dwordx4 v[168:171], v208, s[4:7], s32 offen offset:0
    buffer_load_dwordx4 v[172:175], v216, s[4:7], s32 offen offset:0
    buffer_load_dwordx4 v[32:35], v3, s[4:7], s50 offen offset:0
    buffer_load_dwordx4 v[36:39], v3, s[4:7], s50 offen offset:1024
    buffer_load_dwordx4 v[40:43], v3, s[4:7], s51 offen offset:0
    buffer_load_dwordx4 v[44:47], v3, s[4:7], s51 offen offset:1024
    buffer_load_dwordx4 v[176:179], v3, s[4:7], s33 offen offset:0
    buffer_load_dwordx4 v[180:183], v3, s[4:7], s33 offen offset:1024
    buffer_load_dwordx4 v[184:187], v208, s[4:7], s33 offen offset:0
    buffer_load_dwordx4 v[188:191], v216, s[4:7], s33 offen offset:0
    s_waitcnt vmcnt(12)
    v_and_b32 v16, v209, v16
    v_and_b32 v17, v209, v17
    v_and_b32 v22, v210, v22
    v_and_b32 v23, v210, v23
    v_mfma_f32_32x32x16_bf16 v[112:127], v[160:163], v[16:19], 0
    s_nop 0
    v_mfma_f32_32x32x16_bf16 v[112:127], v[164:167], v[20:23], v[112:127]
    s_waitcnt vmcnt(10)
    v_and_b32 v24, v209, v24
    v_and_b32 v25, v209, v25
    v_and_b32 v30, v210, v30
    v_and_b32 v31, v210, v31
    v_mfma_f32_32x32x16_bf16 v[128:143], v[160:163], v[24:27], 0
    buffer_load_dwordx4 v[192:195], v3, s[4:7], s34 offen offset:0
    s_nop 4
    v_exp_f32 v112, v112
    v_exp_f32 v113, v113
    v_exp_f32 v114, v114
    v_exp_f32 v115, v115
    v_cvt_pk_bf16_f32 v144, v112, v113
    v_cvt_pk_bf16_f32 v145, v114, v115
    v_mfma_f32_32x32x16_bf16 v[128:143], v[164:167], v[28:31], v[128:143]
    v_exp_f32 v116, v116
    v_exp_f32 v117, v117
    v_exp_f32 v118, v118
    v_exp_f32 v119, v119
    v_cvt_pk_bf16_f32 v146, v116, v117
    v_cvt_pk_bf16_f32 v147, v118, v119
    v_exp_f32 v120, v120
    v_exp_f32 v121, v121
    v_exp_f32 v122, v122
    v_exp_f32 v123, v123
    v_cvt_pk_bf16_f32 v148, v120, v121
    v_cvt_pk_bf16_f32 v149, v122, v123
    v_exp_f32 v124, v124
    v_exp_f32 v125, v125
    v_exp_f32 v126, v126
    v_exp_f32 v127, v127
    v_cvt_pk_bf16_f32 v150, v124, v125
    v_cvt_pk_bf16_f32 v151, v126, v127
    s_waitcnt vmcnt(7)
    v_and_b32 v32, v209, v32
    v_and_b32 v33, v209, v33
    v_and_b32 v38, v210, v38
    v_and_b32 v39, v210, v39
    v_mfma_f32_32x32x16_bf16 v[112:127], v[160:163], v[32:35], 0
    buffer_load_dwordx4 v[196:199], v3, s[4:7], s34 offen offset:1024
    v_exp_f32 v128, v128
    v_exp_f32 v129, v129
    v_exp_f32 v130, v130
    v_exp_f32 v131, v131
    v_cvt_pk_bf16_f32 v152, v128, v129
    v_cvt_pk_bf16_f32 v153, v130, v131
    v_mfma_f32_32x32x16_bf16 v[112:127], v[164:167], v[36:39], v[112:127]
    v_exp_f32 v132, v132
    v_exp_f32 v133, v133
    v_exp_f32 v134, v134
    v_exp_f32 v135, v135
    v_cvt_pk_bf16_f32 v154, v132, v133
    v_cvt_pk_bf16_f32 v155, v134, v135
    v_mfma_f32_32x32x16_bf16 v[48:63], v[168:171], v[144:147], 0
    v_exp_f32 v136, v136
    v_exp_f32 v137, v137
    v_exp_f32 v138, v138
    v_exp_f32 v139, v139
    v_cvt_pk_bf16_f32 v156, v136, v137
    v_cvt_pk_bf16_f32 v157, v138, v139
    v_mfma_f32_32x32x16_bf16 v[48:63], v[172:175], v[148:151], v[48:63]
    v_exp_f32 v140, v140
    v_exp_f32 v141, v141
    v_exp_f32 v142, v142
    v_exp_f32 v143, v143
    v_cvt_pk_bf16_f32 v158, v140, v141
    v_cvt_pk_bf16_f32 v159, v142, v143
    s_waitcnt vmcnt(6)
    v_and_b32 v40, v209, v40
    v_and_b32 v41, v209, v41
    v_and_b32 v46, v210, v46
    v_and_b32 v47, v210, v47
    v_mfma_f32_32x32x16_bf16 v[128:143], v[160:163], v[40:43], 0
    buffer_load_dwordx4 v[200:203], v208, s[4:7], s34 offen offset:0
    v_exp_f32 v112, v112
    v_exp_f32 v113, v113
    v_exp_f32 v114, v114
    v_exp_f32 v115, v115
    v_cvt_pk_bf16_f32 v144, v112, v113
    v_cvt_pk_bf16_f32 v145, v114, v115
    v_mfma_f32_32x32x16_bf16 v[128:143], v[164:167], v[44:47], v[128:143]
    v_exp_f32 v116, v116
    v_exp_f32 v117, v117
    v_exp_f32 v118, v118
    v_exp_f32 v119, v119
    v_cvt_pk_bf16_f32 v146, v116, v117
    v_cvt_pk_bf16_f32 v147, v118, v119
    v_mfma_f32_32x32x16_bf16 v[64:79], v[168:171], v[152:155], 0
    v_exp_f32 v120, v120
    v_exp_f32 v121, v121
    v_exp_f32 v122, v122
    v_exp_f32 v123, v123
    v_cvt_pk_bf16_f32 v148, v120, v121
    v_cvt_pk_bf16_f32 v149, v122, v123
    v_mfma_f32_32x32x16_bf16 v[64:79], v[172:175], v[156:159], v[64:79]
    s_waitcnt vmcnt(5)
    v_exp_f32 v124, v124
    v_exp_f32 v125, v125
    v_exp_f32 v126, v126
    v_exp_f32 v127, v127
    v_cvt_pk_bf16_f32 v150, v124, v125
    v_cvt_pk_bf16_f32 v151, v126, v127
    v_mfma_f32_32x32x16_bf16 v[112:127], v[176:179], v[16:19], 0
    buffer_load_dwordx4 v[204:207], v216, s[4:7], s34 offen offset:0
    v_exp_f32 v128, v128
    v_exp_f32 v129, v129
    v_exp_f32 v130, v130
    v_exp_f32 v131, v131
    v_cvt_pk_bf16_f32 v152, v128, v129
    v_cvt_pk_bf16_f32 v153, v130, v131
    v_mfma_f32_32x32x16_bf16 v[112:127], v[180:183], v[20:23], v[112:127]
    v_exp_f32 v132, v132
    v_exp_f32 v133, v133
    v_exp_f32 v134, v134
    v_exp_f32 v135, v135
    v_cvt_pk_bf16_f32 v154, v132, v133
    v_cvt_pk_bf16_f32 v155, v134, v135
    v_mfma_f32_32x32x16_bf16 v[80:95], v[168:171], v[144:147], 0
    v_exp_f32 v136, v136
    v_exp_f32 v137, v137
    v_exp_f32 v138, v138
    v_exp_f32 v139, v139
    v_cvt_pk_bf16_f32 v156, v136, v137
    v_cvt_pk_bf16_f32 v157, v138, v139
    v_mfma_f32_32x32x16_bf16 v[80:95], v[172:175], v[148:151], v[80:95]
    v_exp_f32 v140, v140
    v_exp_f32 v141, v141
    v_exp_f32 v142, v142
    v_exp_f32 v143, v143
    v_cvt_pk_bf16_f32 v158, v140, v141
    v_cvt_pk_bf16_f32 v159, v142, v143
    v_mfma_f32_32x32x16_bf16 v[128:143], v[176:179], v[24:27], 0
    buffer_load_dwordx4 v[160:163], v3, s[4:7], s35 offen offset:0
    v_exp_f32 v112, v112
    v_exp_f32 v113, v113
    v_exp_f32 v114, v114
    v_exp_f32 v115, v115
    v_cvt_pk_bf16_f32 v144, v112, v113
    v_cvt_pk_bf16_f32 v145, v114, v115
    v_mfma_f32_32x32x16_bf16 v[128:143], v[180:183], v[28:31], v[128:143]
    v_exp_f32 v116, v116
    v_exp_f32 v117, v117
    v_exp_f32 v118, v118
    v_exp_f32 v119, v119
    v_cvt_pk_bf16_f32 v146, v116, v117
    v_cvt_pk_bf16_f32 v147, v118, v119
    v_mfma_f32_32x32x16_bf16 v[96:111], v[168:171], v[152:155], 0
    v_exp_f32 v120, v120
    v_exp_f32 v121, v121
    v_exp_f32 v122, v122
    v_exp_f32 v123, v123
    v_cvt_pk_bf16_f32 v148, v120, v121
    v_cvt_pk_bf16_f32 v149, v122, v123
    v_mfma_f32_32x32x16_bf16 v[96:111], v[172:175], v[156:159], v[96:111]
    v_exp_f32 v124, v124
    v_exp_f32 v125, v125
    v_exp_f32 v126, v126
    v_exp_f32 v127, v127
    v_cvt_pk_bf16_f32 v150, v124, v125
    v_cvt_pk_bf16_f32 v151, v126, v127
    v_mfma_f32_32x32x16_bf16 v[112:127], v[176:179], v[32:35], 0
    buffer_load_dwordx4 v[164:167], v3, s[4:7], s35 offen offset:1024
    v_exp_f32 v128, v128
    v_exp_f32 v129, v129
    v_exp_f32 v130, v130
    v_exp_f32 v131, v131
    v_cvt_pk_bf16_f32 v152, v128, v129
    v_cvt_pk_bf16_f32 v153, v130, v131
    v_mfma_f32_32x32x16_bf16 v[112:127], v[180:183], v[36:39], v[112:127]
    s_waitcnt vmcnt(6)
    v_exp_f32 v132, v132
    v_exp_f32 v133, v133
    v_exp_f32 v134, v134
    v_exp_f32 v135, v135
    v_cvt_pk_bf16_f32 v154, v132, v133
    v_cvt_pk_bf16_f32 v155, v134, v135
    v_mfma_f32_32x32x16_bf16 v[48:63], v[184:187], v[144:147], v[48:63]
    v_exp_f32 v136, v136
    v_exp_f32 v137, v137
    v_exp_f32 v138, v138
    v_exp_f32 v139, v139
    v_cvt_pk_bf16_f32 v156, v136, v137
    v_cvt_pk_bf16_f32 v157, v138, v139
    v_mfma_f32_32x32x16_bf16 v[48:63], v[188:191], v[148:151], v[48:63]
    v_exp_f32 v140, v140
    v_exp_f32 v141, v141
    v_exp_f32 v142, v142
    v_exp_f32 v143, v143
    v_cvt_pk_bf16_f32 v158, v140, v141
    v_cvt_pk_bf16_f32 v159, v142, v143
    v_mfma_f32_32x32x16_bf16 v[128:143], v[176:179], v[40:43], 0
    buffer_load_dwordx4 v[168:171], v208, s[4:7], s35 offen offset:0
    v_exp_f32 v112, v112
    v_exp_f32 v113, v113
    v_exp_f32 v114, v114
    v_exp_f32 v115, v115
    v_cvt_pk_bf16_f32 v144, v112, v113
    v_cvt_pk_bf16_f32 v145, v114, v115
    v_mfma_f32_32x32x16_bf16 v[128:143], v[180:183], v[44:47], v[128:143]
    v_exp_f32 v116, v116
    v_exp_f32 v117, v117
    v_exp_f32 v118, v118
    v_exp_f32 v119, v119
    v_cvt_pk_bf16_f32 v146, v116, v117
    v_cvt_pk_bf16_f32 v147, v118, v119
    v_mfma_f32_32x32x16_bf16 v[64:79], v[184:187], v[152:155], v[64:79]
    v_exp_f32 v120, v120
    v_exp_f32 v121, v121
    v_exp_f32 v122, v122
    v_exp_f32 v123, v123
    v_cvt_pk_bf16_f32 v148, v120, v121
    v_cvt_pk_bf16_f32 v149, v122, v123
    v_mfma_f32_32x32x16_bf16 v[64:79], v[188:191], v[156:159], v[64:79]
    s_waitcnt vmcnt(5)
    v_exp_f32 v124, v124
    v_exp_f32 v125, v125
    v_exp_f32 v126, v126
    v_exp_f32 v127, v127
    v_cvt_pk_bf16_f32 v150, v124, v125
    v_cvt_pk_bf16_f32 v151, v126, v127
    v_mfma_f32_32x32x16_bf16 v[112:127], v[192:195], v[16:19], 0
    buffer_load_dwordx4 v[172:175], v216, s[4:7], s35 offen offset:0
    v_exp_f32 v128, v128
    v_exp_f32 v129, v129
    v_exp_f32 v130, v130
    v_exp_f32 v131, v131
    v_cvt_pk_bf16_f32 v152, v128, v129
    v_cvt_pk_bf16_f32 v153, v130, v131
    v_mfma_f32_32x32x16_bf16 v[112:127], v[196:199], v[20:23], v[112:127]
    v_exp_f32 v132, v132
    v_exp_f32 v133, v133
    v_exp_f32 v134, v134
    v_exp_f32 v135, v135
    v_cvt_pk_bf16_f32 v154, v132, v133
    v_cvt_pk_bf16_f32 v155, v134, v135
    v_mfma_f32_32x32x16_bf16 v[80:95], v[184:187], v[144:147], v[80:95]
    v_exp_f32 v136, v136
    v_exp_f32 v137, v137
    v_exp_f32 v138, v138
    v_exp_f32 v139, v139
    v_cvt_pk_bf16_f32 v156, v136, v137
    v_cvt_pk_bf16_f32 v157, v138, v139
    v_mfma_f32_32x32x16_bf16 v[80:95], v[188:191], v[148:151], v[80:95]
    v_exp_f32 v140, v140
    v_exp_f32 v141, v141
    v_exp_f32 v142, v142
    v_exp_f32 v143, v143
    v_cvt_pk_bf16_f32 v158, v140, v141
    v_cvt_pk_bf16_f32 v159, v142, v143
    v_mfma_f32_32x32x16_bf16 v[128:143], v[192:195], v[24:27], 0
    buffer_load_dwordx4 v[176:179], v3, s[4:7], s36 offen offset:0
    v_exp_f32 v112, v112
    v_exp_f32 v113, v113
    v_exp_f32 v114, v114
    v_exp_f32 v115, v115
    v_cvt_pk_bf16_f32 v144, v112, v113
    v_cvt_pk_bf16_f32 v145, v114, v115
    v_mfma_f32_32x32x16_bf16 v[128:143], v[196:199], v[28:31], v[128:143]
    v_exp_f32 v116, v116
    v_exp_f32 v117, v117
    v_exp_f32 v118, v118
    v_exp_f32 v119, v119
    v_cvt_pk_bf16_f32 v146, v116, v117
    v_cvt_pk_bf16_f32 v147, v118, v119
    v_mfma_f32_32x32x16_bf16 v[96:111], v[184:187], v[152:155], v[96:111]
    v_exp_f32 v120, v120
    v_exp_f32 v121, v121
    v_exp_f32 v122, v122
    v_exp_f32 v123, v123
    v_cvt_pk_bf16_f32 v148, v120, v121
    v_cvt_pk_bf16_f32 v149, v122, v123
    v_mfma_f32_32x32x16_bf16 v[96:111], v[188:191], v[156:159], v[96:111]
    v_exp_f32 v124, v124
    v_exp_f32 v125, v125
    v_exp_f32 v126, v126
    v_exp_f32 v127, v127
    v_cvt_pk_bf16_f32 v150, v124, v125
    v_cvt_pk_bf16_f32 v151, v126, v127
    v_mfma_f32_32x32x16_bf16 v[112:127], v[192:195], v[32:35], 0
    buffer_load_dwordx4 v[180:183], v3, s[4:7], s36 offen offset:1024
    v_exp_f32 v128, v128
    v_exp_f32 v129, v129
    v_exp_f32 v130, v130
    v_exp_f32 v131, v131
    v_cvt_pk_bf16_f32 v152, v128, v129
    v_cvt_pk_bf16_f32 v153, v130, v131
    v_mfma_f32_32x32x16_bf16 v[112:127], v[196:199], v[36:39], v[112:127]
    s_waitcnt vmcnt(6)
    v_exp_f32 v132, v132
    v_exp_f32 v133, v133
    v_exp_f32 v134, v134
    v_exp_f32 v135, v135
    v_cvt_pk_bf16_f32 v154, v132, v133
    v_cvt_pk_bf16_f32 v155, v134, v135
    v_mfma_f32_32x32x16_bf16 v[48:63], v[200:203], v[144:147], v[48:63]
    v_exp_f32 v136, v136
    v_exp_f32 v137, v137
    v_exp_f32 v138, v138
    v_exp_f32 v139, v139
    v_cvt_pk_bf16_f32 v156, v136, v137
    v_cvt_pk_bf16_f32 v157, v138, v139
    v_mfma_f32_32x32x16_bf16 v[48:63], v[204:207], v[148:151], v[48:63]
    v_exp_f32 v140, v140
    v_exp_f32 v141, v141
    v_exp_f32 v142, v142
    v_exp_f32 v143, v143
    v_cvt_pk_bf16_f32 v158, v140, v141
    v_cvt_pk_bf16_f32 v159, v142, v143
    v_mfma_f32_32x32x16_bf16 v[128:143], v[192:195], v[40:43], 0
    buffer_load_dwordx4 v[184:187], v208, s[4:7], s36 offen offset:0
    v_exp_f32 v112, v112
    v_exp_f32 v113, v113
    v_exp_f32 v114, v114
    v_exp_f32 v115, v115
    v_cvt_pk_bf16_f32 v144, v112, v113
    v_cvt_pk_bf16_f32 v145, v114, v115
    v_mfma_f32_32x32x16_bf16 v[128:143], v[196:199], v[44:47], v[128:143]
    v_exp_f32 v116, v116
    v_exp_f32 v117, v117
    v_exp_f32 v118, v118
    v_exp_f32 v119, v119
    v_cvt_pk_bf16_f32 v146, v116, v117
    v_cvt_pk_bf16_f32 v147, v118, v119
    v_mfma_f32_32x32x16_bf16 v[64:79], v[200:203], v[152:155], v[64:79]
    v_exp_f32 v120, v120
    v_exp_f32 v121, v121
    v_exp_f32 v122, v122
    v_exp_f32 v123, v123
    v_cvt_pk_bf16_f32 v148, v120, v121
    v_cvt_pk_bf16_f32 v149, v122, v123
    v_mfma_f32_32x32x16_bf16 v[64:79], v[204:207], v[156:159], v[64:79]
    s_waitcnt vmcnt(5)
    v_exp_f32 v124, v124
    v_exp_f32 v125, v125
    v_exp_f32 v126, v126
    v_exp_f32 v127, v127
    v_cvt_pk_bf16_f32 v150, v124, v125
    v_cvt_pk_bf16_f32 v151, v126, v127
    v_mfma_f32_32x32x16_bf16 v[112:127], v[160:163], v[16:19], 0
    buffer_load_dwordx4 v[188:191], v216, s[4:7], s36 offen offset:0
    v_exp_f32 v128, v128
    v_exp_f32 v129, v129
    v_exp_f32 v130, v130
    v_exp_f32 v131, v131
    v_cvt_pk_bf16_f32 v152, v128, v129
    v_cvt_pk_bf16_f32 v153, v130, v131
    v_mfma_f32_32x32x16_bf16 v[112:127], v[164:167], v[20:23], v[112:127]
    v_exp_f32 v132, v132
    v_exp_f32 v133, v133
    v_exp_f32 v134, v134
    v_exp_f32 v135, v135
    v_cvt_pk_bf16_f32 v154, v132, v133
    v_cvt_pk_bf16_f32 v155, v134, v135
    v_mfma_f32_32x32x16_bf16 v[80:95], v[200:203], v[144:147], v[80:95]
    v_exp_f32 v136, v136
    v_exp_f32 v137, v137
    v_exp_f32 v138, v138
    v_exp_f32 v139, v139
    v_cvt_pk_bf16_f32 v156, v136, v137
    v_cvt_pk_bf16_f32 v157, v138, v139
    v_mfma_f32_32x32x16_bf16 v[80:95], v[204:207], v[148:151], v[80:95]
    v_exp_f32 v140, v140
    v_exp_f32 v141, v141
    v_exp_f32 v142, v142
    v_exp_f32 v143, v143
    v_cvt_pk_bf16_f32 v158, v140, v141
    v_cvt_pk_bf16_f32 v159, v142, v143
    v_mfma_f32_32x32x16_bf16 v[128:143], v[160:163], v[24:27], 0
    buffer_load_dwordx4 v[192:195], v3, s[4:7], s37 offen offset:0
    v_exp_f32 v112, v112
    v_exp_f32 v113, v113
    v_exp_f32 v114, v114
    v_exp_f32 v115, v115
    v_cvt_pk_bf16_f32 v144, v112, v113
    v_cvt_pk_bf16_f32 v145, v114, v115
    v_mfma_f32_32x32x16_bf16 v[128:143], v[164:167], v[28:31], v[128:143]
    v_exp_f32 v116, v116
    v_exp_f32 v117, v117
    v_exp_f32 v118, v118
    v_exp_f32 v119, v119
    v_cvt_pk_bf16_f32 v146, v116, v117
    v_cvt_pk_bf16_f32 v147, v118, v119
    v_mfma_f32_32x32x16_bf16 v[96:111], v[200:203], v[152:155], v[96:111]
    v_exp_f32 v120, v120
    v_exp_f32 v121, v121
    v_exp_f32 v122, v122
    v_exp_f32 v123, v123
    v_cvt_pk_bf16_f32 v148, v120, v121
    v_cvt_pk_bf16_f32 v149, v122, v123
    v_mfma_f32_32x32x16_bf16 v[96:111], v[204:207], v[156:159], v[96:111]
    v_exp_f32 v124, v124
    v_exp_f32 v125, v125
    v_exp_f32 v126, v126
    v_exp_f32 v127, v127
    v_cvt_pk_bf16_f32 v150, v124, v125
    v_cvt_pk_bf16_f32 v151, v126, v127
    v_mfma_f32_32x32x16_bf16 v[112:127], v[160:163], v[32:35], 0
    buffer_load_dwordx4 v[196:199], v3, s[4:7], s37 offen offset:1024
    v_exp_f32 v128, v128
    v_exp_f32 v129, v129
    v_exp_f32 v130, v130
    v_exp_f32 v131, v131
    v_cvt_pk_bf16_f32 v152, v128, v129
    v_cvt_pk_bf16_f32 v153, v130, v131
    v_mfma_f32_32x32x16_bf16 v[112:127], v[164:167], v[36:39], v[112:127]
    s_waitcnt vmcnt(6)
    v_exp_f32 v132, v132
    v_exp_f32 v133, v133
    v_exp_f32 v134, v134
    v_exp_f32 v135, v135
    v_cvt_pk_bf16_f32 v154, v132, v133
    v_cvt_pk_bf16_f32 v155, v134, v135
    v_mfma_f32_32x32x16_bf16 v[48:63], v[168:171], v[144:147], v[48:63]
    v_exp_f32 v136, v136
    v_exp_f32 v137, v137
    v_exp_f32 v138, v138
    v_exp_f32 v139, v139
    v_cvt_pk_bf16_f32 v156, v136, v137
    v_cvt_pk_bf16_f32 v157, v138, v139
    v_mfma_f32_32x32x16_bf16 v[48:63], v[172:175], v[148:151], v[48:63]
    v_exp_f32 v140, v140
    v_exp_f32 v141, v141
    v_exp_f32 v142, v142
    v_exp_f32 v143, v143
    v_cvt_pk_bf16_f32 v158, v140, v141
    v_cvt_pk_bf16_f32 v159, v142, v143
    v_mfma_f32_32x32x16_bf16 v[128:143], v[160:163], v[40:43], 0
    buffer_load_dwordx4 v[200:203], v208, s[4:7], s37 offen offset:0
    v_exp_f32 v112, v112
    v_exp_f32 v113, v113
    v_exp_f32 v114, v114
    v_exp_f32 v115, v115
    v_cvt_pk_bf16_f32 v144, v112, v113
    v_cvt_pk_bf16_f32 v145, v114, v115
    v_mfma_f32_32x32x16_bf16 v[128:143], v[164:167], v[44:47], v[128:143]
    v_exp_f32 v116, v116
    v_exp_f32 v117, v117
    v_exp_f32 v118, v118
    v_exp_f32 v119, v119
    v_cvt_pk_bf16_f32 v146, v116, v117
    v_cvt_pk_bf16_f32 v147, v118, v119
    v_mfma_f32_32x32x16_bf16 v[64:79], v[168:171], v[152:155], v[64:79]
    v_exp_f32 v120, v120
    v_exp_f32 v121, v121
    v_exp_f32 v122, v122
    v_exp_f32 v123, v123
    v_cvt_pk_bf16_f32 v148, v120, v121
    v_cvt_pk_bf16_f32 v149, v122, v123
    v_mfma_f32_32x32x16_bf16 v[64:79], v[172:175], v[156:159], v[64:79]
    s_waitcnt vmcnt(5)
    v_exp_f32 v124, v124
    v_exp_f32 v125, v125
    v_exp_f32 v126, v126
    v_exp_f32 v127, v127
    v_cvt_pk_bf16_f32 v150, v124, v125
    v_cvt_pk_bf16_f32 v151, v126, v127
    v_mfma_f32_32x32x16_bf16 v[112:127], v[176:179], v[16:19], 0
    buffer_load_dwordx4 v[204:207], v216, s[4:7], s37 offen offset:0
    v_exp_f32 v128, v128
    v_exp_f32 v129, v129
    v_exp_f32 v130, v130
    v_exp_f32 v131, v131
    v_cvt_pk_bf16_f32 v152, v128, v129
    v_cvt_pk_bf16_f32 v153, v130, v131
    v_mfma_f32_32x32x16_bf16 v[112:127], v[180:183], v[20:23], v[112:127]
    v_exp_f32 v132, v132
    v_exp_f32 v133, v133
    v_exp_f32 v134, v134
    v_exp_f32 v135, v135
    v_cvt_pk_bf16_f32 v154, v132, v133
    v_cvt_pk_bf16_f32 v155, v134, v135
    v_mfma_f32_32x32x16_bf16 v[80:95], v[168:171], v[144:147], v[80:95]
    v_exp_f32 v136, v136
    v_exp_f32 v137, v137
    v_exp_f32 v138, v138
    v_exp_f32 v139, v139
    v_cvt_pk_bf16_f32 v156, v136, v137
    v_cvt_pk_bf16_f32 v157, v138, v139
    v_mfma_f32_32x32x16_bf16 v[80:95], v[172:175], v[148:151], v[80:95]
    v_exp_f32 v140, v140
    v_exp_f32 v141, v141
    v_exp_f32 v142, v142
    v_exp_f32 v143, v143
    v_cvt_pk_bf16_f32 v158, v140, v141
    v_cvt_pk_bf16_f32 v159, v142, v143
    v_mfma_f32_32x32x16_bf16 v[128:143], v[176:179], v[24:27], 0
    buffer_load_dwordx4 v[160:163], v3, s[4:7], s38 offen offset:0
    v_exp_f32 v112, v112
    v_exp_f32 v113, v113
    v_exp_f32 v114, v114
    v_exp_f32 v115, v115
    v_cvt_pk_bf16_f32 v144, v112, v113
    v_cvt_pk_bf16_f32 v145, v114, v115
    v_mfma_f32_32x32x16_bf16 v[128:143], v[180:183], v[28:31], v[128:143]
    v_exp_f32 v116, v116
    v_exp_f32 v117, v117
    v_exp_f32 v118, v118
    v_exp_f32 v119, v119
    v_cvt_pk_bf16_f32 v146, v116, v117
    v_cvt_pk_bf16_f32 v147, v118, v119
    v_mfma_f32_32x32x16_bf16 v[96:111], v[168:171], v[152:155], v[96:111]
    v_exp_f32 v120, v120
    v_exp_f32 v121, v121
    v_exp_f32 v122, v122
    v_exp_f32 v123, v123
    v_cvt_pk_bf16_f32 v148, v120, v121
    v_cvt_pk_bf16_f32 v149, v122, v123
    v_mfma_f32_32x32x16_bf16 v[96:111], v[172:175], v[156:159], v[96:111]
    v_exp_f32 v124, v124
    v_exp_f32 v125, v125
    v_exp_f32 v126, v126
    v_exp_f32 v127, v127
    v_cvt_pk_bf16_f32 v150, v124, v125
    v_cvt_pk_bf16_f32 v151, v126, v127
    v_mfma_f32_32x32x16_bf16 v[112:127], v[176:179], v[32:35], 0
    buffer_load_dwordx4 v[164:167], v3, s[4:7], s38 offen offset:1024
    v_exp_f32 v128, v128
    v_exp_f32 v129, v129
    v_exp_f32 v130, v130
    v_exp_f32 v131, v131
    v_cvt_pk_bf16_f32 v152, v128, v129
    v_cvt_pk_bf16_f32 v153, v130, v131
    v_mfma_f32_32x32x16_bf16 v[112:127], v[180:183], v[36:39], v[112:127]
    s_waitcnt vmcnt(6)
    v_exp_f32 v132, v132
    v_exp_f32 v133, v133
    v_exp_f32 v134, v134
    v_exp_f32 v135, v135
    v_cvt_pk_bf16_f32 v154, v132, v133
    v_cvt_pk_bf16_f32 v155, v134, v135
    v_mfma_f32_32x32x16_bf16 v[48:63], v[184:187], v[144:147], v[48:63]
    v_exp_f32 v136, v136
    v_exp_f32 v137, v137
    v_exp_f32 v138, v138
    v_exp_f32 v139, v139
    v_cvt_pk_bf16_f32 v156, v136, v137
    v_cvt_pk_bf16_f32 v157, v138, v139
    v_mfma_f32_32x32x16_bf16 v[48:63], v[188:191], v[148:151], v[48:63]
    v_exp_f32 v140, v140
    v_exp_f32 v141, v141
    v_exp_f32 v142, v142
    v_exp_f32 v143, v143
    v_cvt_pk_bf16_f32 v158, v140, v141
    v_cvt_pk_bf16_f32 v159, v142, v143
    v_mfma_f32_32x32x16_bf16 v[128:143], v[176:179], v[40:43], 0
    buffer_load_dwordx4 v[168:171], v208, s[4:7], s38 offen offset:0
    v_exp_f32 v112, v112
    v_exp_f32 v113, v113
    v_exp_f32 v114, v114
    v_exp_f32 v115, v115
    v_cvt_pk_bf16_f32 v144, v112, v113
    v_cvt_pk_bf16_f32 v145, v114, v115
    v_mfma_f32_32x32x16_bf16 v[128:143], v[180:183], v[44:47], v[128:143]
    v_exp_f32 v116, v116
    v_exp_f32 v117, v117
    v_exp_f32 v118, v118
    v_exp_f32 v119, v119
    v_cvt_pk_bf16_f32 v146, v116, v117
    v_cvt_pk_bf16_f32 v147, v118, v119
    v_mfma_f32_32x32x16_bf16 v[64:79], v[184:187], v[152:155], v[64:79]
    v_exp_f32 v120, v120
    v_exp_f32 v121, v121
    v_exp_f32 v122, v122
    v_exp_f32 v123, v123
    v_cvt_pk_bf16_f32 v148, v120, v121
    v_cvt_pk_bf16_f32 v149, v122, v123
    v_mfma_f32_32x32x16_bf16 v[64:79], v[188:191], v[156:159], v[64:79]
    s_waitcnt vmcnt(5)
    v_exp_f32 v124, v124
    v_exp_f32 v125, v125
    v_exp_f32 v126, v126
    v_exp_f32 v127, v127
    v_cvt_pk_bf16_f32 v150, v124, v125
    v_cvt_pk_bf16_f32 v151, v126, v127
    v_mfma_f32_32x32x16_bf16 v[112:127], v[192:195], v[16:19], 0
    buffer_load_dwordx4 v[172:175], v216, s[4:7], s38 offen offset:0
    v_exp_f32 v128, v128
    v_exp_f32 v129, v129
    v_exp_f32 v130, v130
    v_exp_f32 v131, v131
    v_cvt_pk_bf16_f32 v152, v128, v129
    v_cvt_pk_bf16_f32 v153, v130, v131
    v_mfma_f32_32x32x16_bf16 v[112:127], v[196:199], v[20:23], v[112:127]
    v_exp_f32 v132, v132
    v_exp_f32 v133, v133
    v_exp_f32 v134, v134
    v_exp_f32 v135, v135
    v_cvt_pk_bf16_f32 v154, v132, v133
    v_cvt_pk_bf16_f32 v155, v134, v135
    v_mfma_f32_32x32x16_bf16 v[80:95], v[184:187], v[144:147], v[80:95]
    v_exp_f32 v136, v136
    v_exp_f32 v137, v137
    v_exp_f32 v138, v138
    v_exp_f32 v139, v139
    v_cvt_pk_bf16_f32 v156, v136, v137
    v_cvt_pk_bf16_f32 v157, v138, v139
    v_mfma_f32_32x32x16_bf16 v[80:95], v[188:191], v[148:151], v[80:95]
    v_exp_f32 v140, v140
    v_exp_f32 v141, v141
    v_exp_f32 v142, v142
    v_exp_f32 v143, v143
    v_cvt_pk_bf16_f32 v158, v140, v141
    v_cvt_pk_bf16_f32 v159, v142, v143
    v_mfma_f32_32x32x16_bf16 v[128:143], v[192:195], v[24:27], 0
    buffer_load_dwordx4 v[176:179], v3, s[4:7], s39 offen offset:0
    v_exp_f32 v112, v112
    v_exp_f32 v113, v113
    v_exp_f32 v114, v114
    v_exp_f32 v115, v115
    v_cvt_pk_bf16_f32 v144, v112, v113
    v_cvt_pk_bf16_f32 v145, v114, v115
    v_mfma_f32_32x32x16_bf16 v[128:143], v[196:199], v[28:31], v[128:143]
    v_exp_f32 v116, v116
    v_exp_f32 v117, v117
    v_exp_f32 v118, v118
    v_exp_f32 v119, v119
    v_cvt_pk_bf16_f32 v146, v116, v117
    v_cvt_pk_bf16_f32 v147, v118, v119
    v_mfma_f32_32x32x16_bf16 v[96:111], v[184:187], v[152:155], v[96:111]
    v_exp_f32 v120, v120
    v_exp_f32 v121, v121
    v_exp_f32 v122, v122
    v_exp_f32 v123, v123
    v_cvt_pk_bf16_f32 v148, v120, v121
    v_cvt_pk_bf16_f32 v149, v122, v123
    v_mfma_f32_32x32x16_bf16 v[96:111], v[188:191], v[156:159], v[96:111]
    v_exp_f32 v124, v124
    v_exp_f32 v125, v125
    v_exp_f32 v126, v126
    v_exp_f32 v127, v127
    v_cvt_pk_bf16_f32 v150, v124, v125
    v_cvt_pk_bf16_f32 v151, v126, v127
    v_mfma_f32_32x32x16_bf16 v[112:127], v[192:195], v[32:35], 0
    buffer_load_dwordx4 v[180:183], v3, s[4:7], s39 offen offset:1024
    v_exp_f32 v128, v128
    v_exp_f32 v129, v129
    v_exp_f32 v130, v130
    v_exp_f32 v131, v131
    v_cvt_pk_bf16_f32 v152, v128, v129
    v_cvt_pk_bf16_f32 v153, v130, v131
    v_mfma_f32_32x32x16_bf16 v[112:127], v[196:199], v[36:39], v[112:127]
    s_waitcnt vmcnt(6)
    v_exp_f32 v132, v132
    v_exp_f32 v133, v133
    v_exp_f32 v134, v134
    v_exp_f32 v135, v135
    v_cvt_pk_bf16_f32 v154, v132, v133
    v_cvt_pk_bf16_f32 v155, v134, v135
    v_mfma_f32_32x32x16_bf16 v[48:63], v[200:203], v[144:147], v[48:63]
    v_exp_f32 v136, v136
    v_exp_f32 v137, v137
    v_exp_f32 v138, v138
    v_exp_f32 v139, v139
    v_cvt_pk_bf16_f32 v156, v136, v137
    v_cvt_pk_bf16_f32 v157, v138, v139
    v_mfma_f32_32x32x16_bf16 v[48:63], v[204:207], v[148:151], v[48:63]
    v_exp_f32 v140, v140
    v_exp_f32 v141, v141
    v_exp_f32 v142, v142
    v_exp_f32 v143, v143
    v_cvt_pk_bf16_f32 v158, v140, v141
    v_cvt_pk_bf16_f32 v159, v142, v143
    v_mfma_f32_32x32x16_bf16 v[128:143], v[192:195], v[40:43], 0
    buffer_load_dwordx4 v[184:187], v208, s[4:7], s39 offen offset:0
    v_exp_f32 v112, v112
    v_exp_f32 v113, v113
    v_exp_f32 v114, v114
    v_exp_f32 v115, v115
    v_cvt_pk_bf16_f32 v144, v112, v113
    v_cvt_pk_bf16_f32 v145, v114, v115
    v_mfma_f32_32x32x16_bf16 v[128:143], v[196:199], v[44:47], v[128:143]
    v_exp_f32 v116, v116
    v_exp_f32 v117, v117
    v_exp_f32 v118, v118
    v_exp_f32 v119, v119
    v_cvt_pk_bf16_f32 v146, v116, v117
    v_cvt_pk_bf16_f32 v147, v118, v119
    v_mfma_f32_32x32x16_bf16 v[64:79], v[200:203], v[152:155], v[64:79]
    v_exp_f32 v120, v120
    v_exp_f32 v121, v121
    v_exp_f32 v122, v122
    v_exp_f32 v123, v123
    v_cvt_pk_bf16_f32 v148, v120, v121
    v_cvt_pk_bf16_f32 v149, v122, v123
    v_mfma_f32_32x32x16_bf16 v[64:79], v[204:207], v[156:159], v[64:79]
    s_waitcnt vmcnt(5)
    v_exp_f32 v124, v124
    v_exp_f32 v125, v125
    v_exp_f32 v126, v126
    v_exp_f32 v127, v127
    v_cvt_pk_bf16_f32 v150, v124, v125
    v_cvt_pk_bf16_f32 v151, v126, v127
    v_mfma_f32_32x32x16_bf16 v[112:127], v[160:163], v[16:19], 0
    buffer_load_dwordx4 v[188:191], v216, s[4:7], s39 offen offset:0
    v_exp_f32 v128, v128
    v_exp_f32 v129, v129
    v_exp_f32 v130, v130
    v_exp_f32 v131, v131
    v_cvt_pk_bf16_f32 v152, v128, v129
    v_cvt_pk_bf16_f32 v153, v130, v131
    v_mfma_f32_32x32x16_bf16 v[112:127], v[164:167], v[20:23], v[112:127]
    v_exp_f32 v132, v132
    v_exp_f32 v133, v133
    v_exp_f32 v134, v134
    v_exp_f32 v135, v135
    v_cvt_pk_bf16_f32 v154, v132, v133
    v_cvt_pk_bf16_f32 v155, v134, v135
    v_mfma_f32_32x32x16_bf16 v[80:95], v[200:203], v[144:147], v[80:95]
    v_exp_f32 v136, v136
    v_exp_f32 v137, v137
    v_exp_f32 v138, v138
    v_exp_f32 v139, v139
    v_cvt_pk_bf16_f32 v156, v136, v137
    v_cvt_pk_bf16_f32 v157, v138, v139
    v_mfma_f32_32x32x16_bf16 v[80:95], v[204:207], v[148:151], v[80:95]
    v_exp_f32 v140, v140
    v_exp_f32 v141, v141
    v_exp_f32 v142, v142
    v_exp_f32 v143, v143
    v_cvt_pk_bf16_f32 v158, v140, v141
    v_cvt_pk_bf16_f32 v159, v142, v143
    v_mfma_f32_32x32x16_bf16 v[128:143], v[160:163], v[24:27], 0
    buffer_load_dwordx4 v[192:195], v3, s[4:7], s40 offen offset:0
    v_exp_f32 v112, v112
    v_exp_f32 v113, v113
    v_exp_f32 v114, v114
    v_exp_f32 v115, v115
    v_cvt_pk_bf16_f32 v144, v112, v113
    v_cvt_pk_bf16_f32 v145, v114, v115
    v_mfma_f32_32x32x16_bf16 v[128:143], v[164:167], v[28:31], v[128:143]
    v_exp_f32 v116, v116
    v_exp_f32 v117, v117
    v_exp_f32 v118, v118
    v_exp_f32 v119, v119
    v_cvt_pk_bf16_f32 v146, v116, v117
    v_cvt_pk_bf16_f32 v147, v118, v119
    v_mfma_f32_32x32x16_bf16 v[96:111], v[200:203], v[152:155], v[96:111]
    v_exp_f32 v120, v120
    v_exp_f32 v121, v121
    v_exp_f32 v122, v122
    v_exp_f32 v123, v123
    v_cvt_pk_bf16_f32 v148, v120, v121
    v_cvt_pk_bf16_f32 v149, v122, v123
    v_mfma_f32_32x32x16_bf16 v[96:111], v[204:207], v[156:159], v[96:111]
    v_exp_f32 v124, v124
    v_exp_f32 v125, v125
    v_exp_f32 v126, v126
    v_exp_f32 v127, v127
    v_cvt_pk_bf16_f32 v150, v124, v125
    v_cvt_pk_bf16_f32 v151, v126, v127
    v_mfma_f32_32x32x16_bf16 v[112:127], v[160:163], v[32:35], 0
    buffer_load_dwordx4 v[196:199], v3, s[4:7], s40 offen offset:1024
    v_exp_f32 v128, v128
    v_exp_f32 v129, v129
    v_exp_f32 v130, v130
    v_exp_f32 v131, v131
    v_cvt_pk_bf16_f32 v152, v128, v129
    v_cvt_pk_bf16_f32 v153, v130, v131
    v_mfma_f32_32x32x16_bf16 v[112:127], v[164:167], v[36:39], v[112:127]
    s_waitcnt vmcnt(6)
    v_exp_f32 v132, v132
    v_exp_f32 v133, v133
    v_exp_f32 v134, v134
    v_exp_f32 v135, v135
    v_cvt_pk_bf16_f32 v154, v132, v133
    v_cvt_pk_bf16_f32 v155, v134, v135
    v_mfma_f32_32x32x16_bf16 v[48:63], v[168:171], v[144:147], v[48:63]
    v_exp_f32 v136, v136
    v_exp_f32 v137, v137
    v_exp_f32 v138, v138
    v_exp_f32 v139, v139
    v_cvt_pk_bf16_f32 v156, v136, v137
    v_cvt_pk_bf16_f32 v157, v138, v139
    v_mfma_f32_32x32x16_bf16 v[48:63], v[172:175], v[148:151], v[48:63]
    v_exp_f32 v140, v140
    v_exp_f32 v141, v141
    v_exp_f32 v142, v142
    v_exp_f32 v143, v143
    v_cvt_pk_bf16_f32 v158, v140, v141
    v_cvt_pk_bf16_f32 v159, v142, v143
    v_mfma_f32_32x32x16_bf16 v[128:143], v[160:163], v[40:43], 0
    buffer_load_dwordx4 v[200:203], v208, s[4:7], s40 offen offset:0
    v_exp_f32 v112, v112
    v_exp_f32 v113, v113
    v_exp_f32 v114, v114
    v_exp_f32 v115, v115
    v_cvt_pk_bf16_f32 v144, v112, v113
    v_cvt_pk_bf16_f32 v145, v114, v115
    v_mfma_f32_32x32x16_bf16 v[128:143], v[164:167], v[44:47], v[128:143]
    v_exp_f32 v116, v116
    v_exp_f32 v117, v117
    v_exp_f32 v118, v118
    v_exp_f32 v119, v119
    v_cvt_pk_bf16_f32 v146, v116, v117
    v_cvt_pk_bf16_f32 v147, v118, v119
    v_mfma_f32_32x32x16_bf16 v[64:79], v[168:171], v[152:155], v[64:79]
    v_exp_f32 v120, v120
    v_exp_f32 v121, v121
    v_exp_f32 v122, v122
    v_exp_f32 v123, v123
    v_cvt_pk_bf16_f32 v148, v120, v121
    v_cvt_pk_bf16_f32 v149, v122, v123
    v_mfma_f32_32x32x16_bf16 v[64:79], v[172:175], v[156:159], v[64:79]
    s_waitcnt vmcnt(5)
    v_exp_f32 v124, v124
    v_exp_f32 v125, v125
    v_exp_f32 v126, v126
    v_exp_f32 v127, v127
    v_cvt_pk_bf16_f32 v150, v124, v125
    v_cvt_pk_bf16_f32 v151, v126, v127
    v_mfma_f32_32x32x16_bf16 v[112:127], v[176:179], v[16:19], 0
    buffer_load_dwordx4 v[204:207], v216, s[4:7], s40 offen offset:0
    v_exp_f32 v128, v128
    v_exp_f32 v129, v129
    v_exp_f32 v130, v130
    v_exp_f32 v131, v131
    v_cvt_pk_bf16_f32 v152, v128, v129
    v_cvt_pk_bf16_f32 v153, v130, v131
    v_mfma_f32_32x32x16_bf16 v[112:127], v[180:183], v[20:23], v[112:127]
    v_exp_f32 v132, v132
    v_exp_f32 v133, v133
    v_exp_f32 v134, v134
    v_exp_f32 v135, v135
    v_cvt_pk_bf16_f32 v154, v132, v133
    v_cvt_pk_bf16_f32 v155, v134, v135
    v_mfma_f32_32x32x16_bf16 v[80:95], v[168:171], v[144:147], v[80:95]
    v_exp_f32 v136, v136
    v_exp_f32 v137, v137
    v_exp_f32 v138, v138
    v_exp_f32 v139, v139
    v_cvt_pk_bf16_f32 v156, v136, v137
    v_cvt_pk_bf16_f32 v157, v138, v139
    v_mfma_f32_32x32x16_bf16 v[80:95], v[172:175], v[148:151], v[80:95]
    v_exp_f32 v140, v140
    v_exp_f32 v141, v141
    v_exp_f32 v142, v142
    v_exp_f32 v143, v143
    v_cvt_pk_bf16_f32 v158, v140, v141
    v_cvt_pk_bf16_f32 v159, v142, v143
    v_mfma_f32_32x32x16_bf16 v[128:143], v[176:179], v[24:27], 0
    buffer_load_dwordx4 v[160:163], v3, s[4:7], s41 offen offset:0
    v_exp_f32 v112, v112
    v_exp_f32 v113, v113
    v_exp_f32 v114, v114
    v_exp_f32 v115, v115
    v_cvt_pk_bf16_f32 v144, v112, v113
    v_cvt_pk_bf16_f32 v145, v114, v115
    v_mfma_f32_32x32x16_bf16 v[128:143], v[180:183], v[28:31], v[128:143]
    v_exp_f32 v116, v116
    v_exp_f32 v117, v117
    v_exp_f32 v118, v118
    v_exp_f32 v119, v119
    v_cvt_pk_bf16_f32 v146, v116, v117
    v_cvt_pk_bf16_f32 v147, v118, v119
    v_mfma_f32_32x32x16_bf16 v[96:111], v[168:171], v[152:155], v[96:111]
    v_exp_f32 v120, v120
    v_exp_f32 v121, v121
    v_exp_f32 v122, v122
    v_exp_f32 v123, v123
    v_cvt_pk_bf16_f32 v148, v120, v121
    v_cvt_pk_bf16_f32 v149, v122, v123
    v_mfma_f32_32x32x16_bf16 v[96:111], v[172:175], v[156:159], v[96:111]
    v_exp_f32 v124, v124
    v_exp_f32 v125, v125
    v_exp_f32 v126, v126
    v_exp_f32 v127, v127
    v_cvt_pk_bf16_f32 v150, v124, v125
    v_cvt_pk_bf16_f32 v151, v126, v127
    v_mfma_f32_32x32x16_bf16 v[112:127], v[176:179], v[32:35], 0
    buffer_load_dwordx4 v[164:167], v3, s[4:7], s41 offen offset:1024
    v_exp_f32 v128, v128
    v_exp_f32 v129, v129
    v_exp_f32 v130, v130
    v_exp_f32 v131, v131
    v_cvt_pk_bf16_f32 v152, v128, v129
    v_cvt_pk_bf16_f32 v153, v130, v131
    v_mfma_f32_32x32x16_bf16 v[112:127], v[180:183], v[36:39], v[112:127]
    s_waitcnt vmcnt(6)
    v_exp_f32 v132, v132
    v_exp_f32 v133, v133
    v_exp_f32 v134, v134
    v_exp_f32 v135, v135
    v_cvt_pk_bf16_f32 v154, v132, v133
    v_cvt_pk_bf16_f32 v155, v134, v135
    v_mfma_f32_32x32x16_bf16 v[48:63], v[184:187], v[144:147], v[48:63]
    v_exp_f32 v136, v136
    v_exp_f32 v137, v137
    v_exp_f32 v138, v138
    v_exp_f32 v139, v139
    v_cvt_pk_bf16_f32 v156, v136, v137
    v_cvt_pk_bf16_f32 v157, v138, v139
    v_mfma_f32_32x32x16_bf16 v[48:63], v[188:191], v[148:151], v[48:63]
    v_exp_f32 v140, v140
    v_exp_f32 v141, v141
    v_exp_f32 v142, v142
    v_exp_f32 v143, v143
    v_cvt_pk_bf16_f32 v158, v140, v141
    v_cvt_pk_bf16_f32 v159, v142, v143
    v_mfma_f32_32x32x16_bf16 v[128:143], v[176:179], v[40:43], 0
    buffer_load_dwordx4 v[168:171], v208, s[4:7], s41 offen offset:0
    v_exp_f32 v112, v112
    v_exp_f32 v113, v113
    v_exp_f32 v114, v114
    v_exp_f32 v115, v115
    v_cvt_pk_bf16_f32 v144, v112, v113
    v_cvt_pk_bf16_f32 v145, v114, v115
    v_mfma_f32_32x32x16_bf16 v[128:143], v[180:183], v[44:47], v[128:143]
    v_exp_f32 v116, v116
    v_exp_f32 v117, v117
    v_exp_f32 v118, v118
    v_exp_f32 v119, v119
    v_cvt_pk_bf16_f32 v146, v116, v117
    v_cvt_pk_bf16_f32 v147, v118, v119
    v_mfma_f32_32x32x16_bf16 v[64:79], v[184:187], v[152:155], v[64:79]
    v_exp_f32 v120, v120
    v_exp_f32 v121, v121
    v_exp_f32 v122, v122
    v_exp_f32 v123, v123
    v_cvt_pk_bf16_f32 v148, v120, v121
    v_cvt_pk_bf16_f32 v149, v122, v123
    v_mfma_f32_32x32x16_bf16 v[64:79], v[188:191], v[156:159], v[64:79]
    s_waitcnt vmcnt(5)
    v_exp_f32 v124, v124
    v_exp_f32 v125, v125
    v_exp_f32 v126, v126
    v_exp_f32 v127, v127
    v_cvt_pk_bf16_f32 v150, v124, v125
    v_cvt_pk_bf16_f32 v151, v126, v127
    v_mfma_f32_32x32x16_bf16 v[112:127], v[192:195], v[16:19], 0
    buffer_load_dwordx4 v[172:175], v216, s[4:7], s41 offen offset:0
    v_exp_f32 v128, v128
    v_exp_f32 v129, v129
    v_exp_f32 v130, v130
    v_exp_f32 v131, v131
    v_cvt_pk_bf16_f32 v152, v128, v129
    v_cvt_pk_bf16_f32 v153, v130, v131
    v_mfma_f32_32x32x16_bf16 v[112:127], v[196:199], v[20:23], v[112:127]
    v_exp_f32 v132, v132
    v_exp_f32 v133, v133
    v_exp_f32 v134, v134
    v_exp_f32 v135, v135
    v_cvt_pk_bf16_f32 v154, v132, v133
    v_cvt_pk_bf16_f32 v155, v134, v135
    v_mfma_f32_32x32x16_bf16 v[80:95], v[184:187], v[144:147], v[80:95]
    v_exp_f32 v136, v136
    v_exp_f32 v137, v137
    v_exp_f32 v138, v138
    v_exp_f32 v139, v139
    v_cvt_pk_bf16_f32 v156, v136, v137
    v_cvt_pk_bf16_f32 v157, v138, v139
    v_mfma_f32_32x32x16_bf16 v[80:95], v[188:191], v[148:151], v[80:95]
    v_exp_f32 v140, v140
    v_exp_f32 v141, v141
    v_exp_f32 v142, v142
    v_exp_f32 v143, v143
    v_cvt_pk_bf16_f32 v158, v140, v141
    v_cvt_pk_bf16_f32 v159, v142, v143
    v_mfma_f32_32x32x16_bf16 v[128:143], v[192:195], v[24:27], 0
    buffer_load_dwordx4 v[176:179], v3, s[4:7], s42 offen offset:0
    v_exp_f32 v112, v112
    v_exp_f32 v113, v113
    v_exp_f32 v114, v114
    v_exp_f32 v115, v115
    v_cvt_pk_bf16_f32 v144, v112, v113
    v_cvt_pk_bf16_f32 v145, v114, v115
    v_mfma_f32_32x32x16_bf16 v[128:143], v[196:199], v[28:31], v[128:143]
    v_exp_f32 v116, v116
    v_exp_f32 v117, v117
    v_exp_f32 v118, v118
    v_exp_f32 v119, v119
    v_cvt_pk_bf16_f32 v146, v116, v117
    v_cvt_pk_bf16_f32 v147, v118, v119
    v_mfma_f32_32x32x16_bf16 v[96:111], v[184:187], v[152:155], v[96:111]
    v_exp_f32 v120, v120
    v_exp_f32 v121, v121
    v_exp_f32 v122, v122
    v_exp_f32 v123, v123
    v_cvt_pk_bf16_f32 v148, v120, v121
    v_cvt_pk_bf16_f32 v149, v122, v123
    v_mfma_f32_32x32x16_bf16 v[96:111], v[188:191], v[156:159], v[96:111]
    v_exp_f32 v124, v124
    v_exp_f32 v125, v125
    v_exp_f32 v126, v126
    v_exp_f32 v127, v127
    v_cvt_pk_bf16_f32 v150, v124, v125
    v_cvt_pk_bf16_f32 v151, v126, v127
    v_mfma_f32_32x32x16_bf16 v[112:127], v[192:195], v[32:35], 0
    buffer_load_dwordx4 v[180:183], v3, s[4:7], s42 offen offset:1024
    v_exp_f32 v128, v128
    v_exp_f32 v129, v129
    v_exp_f32 v130, v130
    v_exp_f32 v131, v131
    v_cvt_pk_bf16_f32 v152, v128, v129
    v_cvt_pk_bf16_f32 v153, v130, v131
    v_mfma_f32_32x32x16_bf16 v[112:127], v[196:199], v[36:39], v[112:127]
    s_waitcnt vmcnt(6)
    v_exp_f32 v132, v132
    v_exp_f32 v133, v133
    v_exp_f32 v134, v134
    v_exp_f32 v135, v135
    v_cvt_pk_bf16_f32 v154, v132, v133
    v_cvt_pk_bf16_f32 v155, v134, v135
    v_mfma_f32_32x32x16_bf16 v[48:63], v[200:203], v[144:147], v[48:63]
    v_exp_f32 v136, v136
    v_exp_f32 v137, v137
    v_exp_f32 v138, v138
    v_exp_f32 v139, v139
    v_cvt_pk_bf16_f32 v156, v136, v137
    v_cvt_pk_bf16_f32 v157, v138, v139
    v_mfma_f32_32x32x16_bf16 v[48:63], v[204:207], v[148:151], v[48:63]
    v_exp_f32 v140, v140
    v_exp_f32 v141, v141
    v_exp_f32 v142, v142
    v_exp_f32 v143, v143
    v_cvt_pk_bf16_f32 v158, v140, v141
    v_cvt_pk_bf16_f32 v159, v142, v143
    v_mfma_f32_32x32x16_bf16 v[128:143], v[192:195], v[40:43], 0
    buffer_load_dwordx4 v[184:187], v208, s[4:7], s42 offen offset:0
    v_exp_f32 v112, v112
    v_exp_f32 v113, v113
    v_exp_f32 v114, v114
    v_exp_f32 v115, v115
    v_cvt_pk_bf16_f32 v144, v112, v113
    v_cvt_pk_bf16_f32 v145, v114, v115
    v_mfma_f32_32x32x16_bf16 v[128:143], v[196:199], v[44:47], v[128:143]
    v_exp_f32 v116, v116
    v_exp_f32 v117, v117
    v_exp_f32 v118, v118
    v_exp_f32 v119, v119
    v_cvt_pk_bf16_f32 v146, v116, v117
    v_cvt_pk_bf16_f32 v147, v118, v119
    v_mfma_f32_32x32x16_bf16 v[64:79], v[200:203], v[152:155], v[64:79]
    v_exp_f32 v120, v120
    v_exp_f32 v121, v121
    v_exp_f32 v122, v122
    v_exp_f32 v123, v123
    v_cvt_pk_bf16_f32 v148, v120, v121
    v_cvt_pk_bf16_f32 v149, v122, v123
    v_mfma_f32_32x32x16_bf16 v[64:79], v[204:207], v[156:159], v[64:79]
    s_waitcnt vmcnt(5)
    v_exp_f32 v124, v124
    v_exp_f32 v125, v125
    v_exp_f32 v126, v126
    v_exp_f32 v127, v127
    v_cvt_pk_bf16_f32 v150, v124, v125
    v_cvt_pk_bf16_f32 v151, v126, v127
    v_mfma_f32_32x32x16_bf16 v[112:127], v[160:163], v[16:19], 0
    buffer_load_dwordx4 v[188:191], v216, s[4:7], s42 offen offset:0
    v_exp_f32 v128, v128
    v_exp_f32 v129, v129
    v_exp_f32 v130, v130
    v_exp_f32 v131, v131
    v_cvt_pk_bf16_f32 v152, v128, v129
    v_cvt_pk_bf16_f32 v153, v130, v131
    v_mfma_f32_32x32x16_bf16 v[112:127], v[164:167], v[20:23], v[112:127]
    v_exp_f32 v132, v132
    v_exp_f32 v133, v133
    v_exp_f32 v134, v134
    v_exp_f32 v135, v135
    v_cvt_pk_bf16_f32 v154, v132, v133
    v_cvt_pk_bf16_f32 v155, v134, v135
    v_mfma_f32_32x32x16_bf16 v[80:95], v[200:203], v[144:147], v[80:95]
    v_exp_f32 v136, v136
    v_exp_f32 v137, v137
    v_exp_f32 v138, v138
    v_exp_f32 v139, v139
    v_cvt_pk_bf16_f32 v156, v136, v137
    v_cvt_pk_bf16_f32 v157, v138, v139
    v_mfma_f32_32x32x16_bf16 v[80:95], v[204:207], v[148:151], v[80:95]
    v_exp_f32 v140, v140
    v_exp_f32 v141, v141
    v_exp_f32 v142, v142
    v_exp_f32 v143, v143
    v_cvt_pk_bf16_f32 v158, v140, v141
    v_cvt_pk_bf16_f32 v159, v142, v143
    v_mfma_f32_32x32x16_bf16 v[128:143], v[160:163], v[24:27], 0
    buffer_load_dwordx4 v[192:195], v3, s[4:7], s43 offen offset:0
    v_exp_f32 v112, v112
    v_exp_f32 v113, v113
    v_exp_f32 v114, v114
    v_exp_f32 v115, v115
    v_cvt_pk_bf16_f32 v144, v112, v113
    v_cvt_pk_bf16_f32 v145, v114, v115
    v_mfma_f32_32x32x16_bf16 v[128:143], v[164:167], v[28:31], v[128:143]
    v_exp_f32 v116, v116
    v_exp_f32 v117, v117
    v_exp_f32 v118, v118
    v_exp_f32 v119, v119
    v_cvt_pk_bf16_f32 v146, v116, v117
    v_cvt_pk_bf16_f32 v147, v118, v119
    v_mfma_f32_32x32x16_bf16 v[96:111], v[200:203], v[152:155], v[96:111]
    v_exp_f32 v120, v120
    v_exp_f32 v121, v121
    v_exp_f32 v122, v122
    v_exp_f32 v123, v123
    v_cvt_pk_bf16_f32 v148, v120, v121
    v_cvt_pk_bf16_f32 v149, v122, v123
    v_mfma_f32_32x32x16_bf16 v[96:111], v[204:207], v[156:159], v[96:111]
    v_exp_f32 v124, v124
    v_exp_f32 v125, v125
    v_exp_f32 v126, v126
    v_exp_f32 v127, v127
    v_cvt_pk_bf16_f32 v150, v124, v125
    v_cvt_pk_bf16_f32 v151, v126, v127
    v_mfma_f32_32x32x16_bf16 v[112:127], v[160:163], v[32:35], 0
    buffer_load_dwordx4 v[196:199], v3, s[4:7], s43 offen offset:1024
    v_exp_f32 v128, v128
    v_exp_f32 v129, v129
    v_exp_f32 v130, v130
    v_exp_f32 v131, v131
    v_cvt_pk_bf16_f32 v152, v128, v129
    v_cvt_pk_bf16_f32 v153, v130, v131
    v_mfma_f32_32x32x16_bf16 v[112:127], v[164:167], v[36:39], v[112:127]
    s_waitcnt vmcnt(6)
    v_exp_f32 v132, v132
    v_exp_f32 v133, v133
    v_exp_f32 v134, v134
    v_exp_f32 v135, v135
    v_cvt_pk_bf16_f32 v154, v132, v133
    v_cvt_pk_bf16_f32 v155, v134, v135
    v_mfma_f32_32x32x16_bf16 v[48:63], v[168:171], v[144:147], v[48:63]
    v_exp_f32 v136, v136
    v_exp_f32 v137, v137
    v_exp_f32 v138, v138
    v_exp_f32 v139, v139
    v_cvt_pk_bf16_f32 v156, v136, v137
    v_cvt_pk_bf16_f32 v157, v138, v139
    v_mfma_f32_32x32x16_bf16 v[48:63], v[172:175], v[148:151], v[48:63]
    v_exp_f32 v140, v140
    v_exp_f32 v141, v141
    v_exp_f32 v142, v142
    v_exp_f32 v143, v143
    v_cvt_pk_bf16_f32 v158, v140, v141
    v_cvt_pk_bf16_f32 v159, v142, v143
    v_mfma_f32_32x32x16_bf16 v[128:143], v[160:163], v[40:43], 0
    buffer_load_dwordx4 v[200:203], v208, s[4:7], s43 offen offset:0
    v_exp_f32 v112, v112
    v_exp_f32 v113, v113
    v_exp_f32 v114, v114
    v_exp_f32 v115, v115
    v_cvt_pk_bf16_f32 v144, v112, v113
    v_cvt_pk_bf16_f32 v145, v114, v115
    v_mfma_f32_32x32x16_bf16 v[128:143], v[164:167], v[44:47], v[128:143]
    v_exp_f32 v116, v116
    v_exp_f32 v117, v117
    v_exp_f32 v118, v118
    v_exp_f32 v119, v119
    v_cvt_pk_bf16_f32 v146, v116, v117
    v_cvt_pk_bf16_f32 v147, v118, v119
    v_mfma_f32_32x32x16_bf16 v[64:79], v[168:171], v[152:155], v[64:79]
    v_exp_f32 v120, v120
    v_exp_f32 v121, v121
    v_exp_f32 v122, v122
    v_exp_f32 v123, v123
    v_cvt_pk_bf16_f32 v148, v120, v121
    v_cvt_pk_bf16_f32 v149, v122, v123
    v_mfma_f32_32x32x16_bf16 v[64:79], v[172:175], v[156:159], v[64:79]
    s_waitcnt vmcnt(5)
    v_exp_f32 v124, v124
    v_exp_f32 v125, v125
    v_exp_f32 v126, v126
    v_exp_f32 v127, v127
    v_cvt_pk_bf16_f32 v150, v124, v125
    v_cvt_pk_bf16_f32 v151, v126, v127
    v_mfma_f32_32x32x16_bf16 v[112:127], v[176:179], v[16:19], 0
    buffer_load_dwordx4 v[204:207], v216, s[4:7], s43 offen offset:0
    v_exp_f32 v128, v128
    v_exp_f32 v129, v129
    v_exp_f32 v130, v130
    v_exp_f32 v131, v131
    v_cvt_pk_bf16_f32 v152, v128, v129
    v_cvt_pk_bf16_f32 v153, v130, v131
    v_mfma_f32_32x32x16_bf16 v[112:127], v[180:183], v[20:23], v[112:127]
    v_exp_f32 v132, v132
    v_exp_f32 v133, v133
    v_exp_f32 v134, v134
    v_exp_f32 v135, v135
    v_cvt_pk_bf16_f32 v154, v132, v133
    v_cvt_pk_bf16_f32 v155, v134, v135
    v_mfma_f32_32x32x16_bf16 v[80:95], v[168:171], v[144:147], v[80:95]
    v_exp_f32 v136, v136
    v_exp_f32 v137, v137
    v_exp_f32 v138, v138
    v_exp_f32 v139, v139
    v_cvt_pk_bf16_f32 v156, v136, v137
    v_cvt_pk_bf16_f32 v157, v138, v139
    v_mfma_f32_32x32x16_bf16 v[80:95], v[172:175], v[148:151], v[80:95]
    v_exp_f32 v140, v140
    v_exp_f32 v141, v141
    v_exp_f32 v142, v142
    v_exp_f32 v143, v143
    v_cvt_pk_bf16_f32 v158, v140, v141
    v_cvt_pk_bf16_f32 v159, v142, v143
    v_mfma_f32_32x32x16_bf16 v[128:143], v[176:179], v[24:27], 0
    buffer_load_dwordx4 v[160:163], v3, s[4:7], s44 offen offset:0
    v_exp_f32 v112, v112
    v_exp_f32 v113, v113
    v_exp_f32 v114, v114
    v_exp_f32 v115, v115
    v_cvt_pk_bf16_f32 v144, v112, v113
    v_cvt_pk_bf16_f32 v145, v114, v115
    v_mfma_f32_32x32x16_bf16 v[128:143], v[180:183], v[28:31], v[128:143]
    v_exp_f32 v116, v116
    v_exp_f32 v117, v117
    v_exp_f32 v118, v118
    v_exp_f32 v119, v119
    v_cvt_pk_bf16_f32 v146, v116, v117
    v_cvt_pk_bf16_f32 v147, v118, v119
    v_mfma_f32_32x32x16_bf16 v[96:111], v[168:171], v[152:155], v[96:111]
    v_exp_f32 v120, v120
    v_exp_f32 v121, v121
    v_exp_f32 v122, v122
    v_exp_f32 v123, v123
    v_cvt_pk_bf16_f32 v148, v120, v121
    v_cvt_pk_bf16_f32 v149, v122, v123
    v_mfma_f32_32x32x16_bf16 v[96:111], v[172:175], v[156:159], v[96:111]
    v_exp_f32 v124, v124
    v_exp_f32 v125, v125
    v_exp_f32 v126, v126
    v_exp_f32 v127, v127
    v_cvt_pk_bf16_f32 v150, v124, v125
    v_cvt_pk_bf16_f32 v151, v126, v127
    v_mfma_f32_32x32x16_bf16 v[112:127], v[176:179], v[32:35], 0
    buffer_load_dwordx4 v[164:167], v3, s[4:7], s44 offen offset:1024
    v_exp_f32 v128, v128
    v_exp_f32 v129, v129
    v_exp_f32 v130, v130
    v_exp_f32 v131, v131
    v_cvt_pk_bf16_f32 v152, v128, v129
    v_cvt_pk_bf16_f32 v153, v130, v131
    v_mfma_f32_32x32x16_bf16 v[112:127], v[180:183], v[36:39], v[112:127]
    s_waitcnt vmcnt(6)
    v_exp_f32 v132, v132
    v_exp_f32 v133, v133
    v_exp_f32 v134, v134
    v_exp_f32 v135, v135
    v_cvt_pk_bf16_f32 v154, v132, v133
    v_cvt_pk_bf16_f32 v155, v134, v135
    v_mfma_f32_32x32x16_bf16 v[48:63], v[184:187], v[144:147], v[48:63]
    v_exp_f32 v136, v136
    v_exp_f32 v137, v137
    v_exp_f32 v138, v138
    v_exp_f32 v139, v139
    v_cvt_pk_bf16_f32 v156, v136, v137
    v_cvt_pk_bf16_f32 v157, v138, v139
    v_mfma_f32_32x32x16_bf16 v[48:63], v[188:191], v[148:151], v[48:63]
    v_exp_f32 v140, v140
    v_exp_f32 v141, v141
    v_exp_f32 v142, v142
    v_exp_f32 v143, v143
    v_cvt_pk_bf16_f32 v158, v140, v141
    v_cvt_pk_bf16_f32 v159, v142, v143
    v_mfma_f32_32x32x16_bf16 v[128:143], v[176:179], v[40:43], 0
    buffer_load_dwordx4 v[168:171], v208, s[4:7], s44 offen offset:0
    v_exp_f32 v112, v112
    v_exp_f32 v113, v113
    v_exp_f32 v114, v114
    v_exp_f32 v115, v115
    v_cvt_pk_bf16_f32 v144, v112, v113
    v_cvt_pk_bf16_f32 v145, v114, v115
    v_mfma_f32_32x32x16_bf16 v[128:143], v[180:183], v[44:47], v[128:143]
    v_exp_f32 v116, v116
    v_exp_f32 v117, v117
    v_exp_f32 v118, v118
    v_exp_f32 v119, v119
    v_cvt_pk_bf16_f32 v146, v116, v117
    v_cvt_pk_bf16_f32 v147, v118, v119
    v_mfma_f32_32x32x16_bf16 v[64:79], v[184:187], v[152:155], v[64:79]
    v_exp_f32 v120, v120
    v_exp_f32 v121, v121
    v_exp_f32 v122, v122
    v_exp_f32 v123, v123
    v_cvt_pk_bf16_f32 v148, v120, v121
    v_cvt_pk_bf16_f32 v149, v122, v123
    v_mfma_f32_32x32x16_bf16 v[64:79], v[188:191], v[156:159], v[64:79]
    s_waitcnt vmcnt(5)
    v_exp_f32 v124, v124
    v_exp_f32 v125, v125
    v_exp_f32 v126, v126
    v_exp_f32 v127, v127
    v_cvt_pk_bf16_f32 v150, v124, v125
    v_cvt_pk_bf16_f32 v151, v126, v127
    v_mfma_f32_32x32x16_bf16 v[112:127], v[192:195], v[16:19], 0
    buffer_load_dwordx4 v[172:175], v216, s[4:7], s44 offen offset:0
    v_exp_f32 v128, v128
    v_exp_f32 v129, v129
    v_exp_f32 v130, v130
    v_exp_f32 v131, v131
    v_cvt_pk_bf16_f32 v152, v128, v129
    v_cvt_pk_bf16_f32 v153, v130, v131
    v_mfma_f32_32x32x16_bf16 v[112:127], v[196:199], v[20:23], v[112:127]
    v_exp_f32 v132, v132
    v_exp_f32 v133, v133
    v_exp_f32 v134, v134
    v_exp_f32 v135, v135
    v_cvt_pk_bf16_f32 v154, v132, v133
    v_cvt_pk_bf16_f32 v155, v134, v135
    v_mfma_f32_32x32x16_bf16 v[80:95], v[184:187], v[144:147], v[80:95]
    v_exp_f32 v136, v136
    v_exp_f32 v137, v137
    v_exp_f32 v138, v138
    v_exp_f32 v139, v139
    v_cvt_pk_bf16_f32 v156, v136, v137
    v_cvt_pk_bf16_f32 v157, v138, v139
    v_mfma_f32_32x32x16_bf16 v[80:95], v[188:191], v[148:151], v[80:95]
    v_exp_f32 v140, v140
    v_exp_f32 v141, v141
    v_exp_f32 v142, v142
    v_exp_f32 v143, v143
    v_cvt_pk_bf16_f32 v158, v140, v141
    v_cvt_pk_bf16_f32 v159, v142, v143
    v_mfma_f32_32x32x16_bf16 v[128:143], v[192:195], v[24:27], 0
    buffer_load_dwordx4 v[176:179], v3, s[4:7], s45 offen offset:0
    v_exp_f32 v112, v112
    v_exp_f32 v113, v113
    v_exp_f32 v114, v114
    v_exp_f32 v115, v115
    v_cvt_pk_bf16_f32 v144, v112, v113
    v_cvt_pk_bf16_f32 v145, v114, v115
    v_mfma_f32_32x32x16_bf16 v[128:143], v[196:199], v[28:31], v[128:143]
    v_exp_f32 v116, v116
    v_exp_f32 v117, v117
    v_exp_f32 v118, v118
    v_exp_f32 v119, v119
    v_cvt_pk_bf16_f32 v146, v116, v117
    v_cvt_pk_bf16_f32 v147, v118, v119
    v_mfma_f32_32x32x16_bf16 v[96:111], v[184:187], v[152:155], v[96:111]
    v_exp_f32 v120, v120
    v_exp_f32 v121, v121
    v_exp_f32 v122, v122
    v_exp_f32 v123, v123
    v_cvt_pk_bf16_f32 v148, v120, v121
    v_cvt_pk_bf16_f32 v149, v122, v123
    v_mfma_f32_32x32x16_bf16 v[96:111], v[188:191], v[156:159], v[96:111]
    v_exp_f32 v124, v124
    v_exp_f32 v125, v125
    v_exp_f32 v126, v126
    v_exp_f32 v127, v127
    v_cvt_pk_bf16_f32 v150, v124, v125
    v_cvt_pk_bf16_f32 v151, v126, v127
    v_mfma_f32_32x32x16_bf16 v[112:127], v[192:195], v[32:35], 0
    buffer_load_dwordx4 v[180:183], v3, s[4:7], s45 offen offset:1024
    v_exp_f32 v128, v128
    v_exp_f32 v129, v129
    v_exp_f32 v130, v130
    v_exp_f32 v131, v131
    v_cvt_pk_bf16_f32 v152, v128, v129
    v_cvt_pk_bf16_f32 v153, v130, v131
    v_mfma_f32_32x32x16_bf16 v[112:127], v[196:199], v[36:39], v[112:127]
    s_waitcnt vmcnt(6)
    v_exp_f32 v132, v132
    v_exp_f32 v133, v133
    v_exp_f32 v134, v134
    v_exp_f32 v135, v135
    v_cvt_pk_bf16_f32 v154, v132, v133
    v_cvt_pk_bf16_f32 v155, v134, v135
    v_mfma_f32_32x32x16_bf16 v[48:63], v[200:203], v[144:147], v[48:63]
    v_exp_f32 v136, v136
    v_exp_f32 v137, v137
    v_exp_f32 v138, v138
    v_exp_f32 v139, v139
    v_cvt_pk_bf16_f32 v156, v136, v137
    v_cvt_pk_bf16_f32 v157, v138, v139
    v_mfma_f32_32x32x16_bf16 v[48:63], v[204:207], v[148:151], v[48:63]
    v_exp_f32 v140, v140
    v_exp_f32 v141, v141
    v_exp_f32 v142, v142
    v_exp_f32 v143, v143
    v_cvt_pk_bf16_f32 v158, v140, v141
    v_cvt_pk_bf16_f32 v159, v142, v143
    v_mfma_f32_32x32x16_bf16 v[128:143], v[192:195], v[40:43], 0
    buffer_load_dwordx4 v[184:187], v208, s[4:7], s45 offen offset:0
    v_exp_f32 v112, v112
    v_exp_f32 v113, v113
    v_exp_f32 v114, v114
    v_exp_f32 v115, v115
    v_cvt_pk_bf16_f32 v144, v112, v113
    v_cvt_pk_bf16_f32 v145, v114, v115
    v_mfma_f32_32x32x16_bf16 v[128:143], v[196:199], v[44:47], v[128:143]
    v_exp_f32 v116, v116
    v_exp_f32 v117, v117
    v_exp_f32 v118, v118
    v_exp_f32 v119, v119
    v_cvt_pk_bf16_f32 v146, v116, v117
    v_cvt_pk_bf16_f32 v147, v118, v119
    v_mfma_f32_32x32x16_bf16 v[64:79], v[200:203], v[152:155], v[64:79]
    v_exp_f32 v120, v120
    v_exp_f32 v121, v121
    v_exp_f32 v122, v122
    v_exp_f32 v123, v123
    v_cvt_pk_bf16_f32 v148, v120, v121
    v_cvt_pk_bf16_f32 v149, v122, v123
    v_mfma_f32_32x32x16_bf16 v[64:79], v[204:207], v[156:159], v[64:79]
    s_waitcnt vmcnt(5)
    v_exp_f32 v124, v124
    v_exp_f32 v125, v125
    v_exp_f32 v126, v126
    v_exp_f32 v127, v127
    v_cvt_pk_bf16_f32 v150, v124, v125
    v_cvt_pk_bf16_f32 v151, v126, v127
    v_mfma_f32_32x32x16_bf16 v[112:127], v[160:163], v[16:19], 0
    buffer_load_dwordx4 v[188:191], v216, s[4:7], s45 offen offset:0
    v_exp_f32 v128, v128
    v_exp_f32 v129, v129
    v_exp_f32 v130, v130
    v_exp_f32 v131, v131
    v_cvt_pk_bf16_f32 v152, v128, v129
    v_cvt_pk_bf16_f32 v153, v130, v131
    v_mfma_f32_32x32x16_bf16 v[112:127], v[164:167], v[20:23], v[112:127]
    v_exp_f32 v132, v132
    v_exp_f32 v133, v133
    v_exp_f32 v134, v134
    v_exp_f32 v135, v135
    v_cvt_pk_bf16_f32 v154, v132, v133
    v_cvt_pk_bf16_f32 v155, v134, v135
    v_mfma_f32_32x32x16_bf16 v[80:95], v[200:203], v[144:147], v[80:95]
    v_exp_f32 v136, v136
    v_exp_f32 v137, v137
    v_exp_f32 v138, v138
    v_exp_f32 v139, v139
    v_cvt_pk_bf16_f32 v156, v136, v137
    v_cvt_pk_bf16_f32 v157, v138, v139
    v_mfma_f32_32x32x16_bf16 v[80:95], v[204:207], v[148:151], v[80:95]
    v_exp_f32 v140, v140
    v_exp_f32 v141, v141
    v_exp_f32 v142, v142
    v_exp_f32 v143, v143
    v_cvt_pk_bf16_f32 v158, v140, v141
    v_cvt_pk_bf16_f32 v159, v142, v143
    v_mfma_f32_32x32x16_bf16 v[128:143], v[160:163], v[24:27], 0
    buffer_load_dwordx4 v[192:195], v3, s[4:7], s46 offen offset:0
    v_exp_f32 v112, v112
    v_exp_f32 v113, v113
    v_exp_f32 v114, v114
    v_exp_f32 v115, v115
    v_cvt_pk_bf16_f32 v144, v112, v113
    v_cvt_pk_bf16_f32 v145, v114, v115
    v_mfma_f32_32x32x16_bf16 v[128:143], v[164:167], v[28:31], v[128:143]
    v_exp_f32 v116, v116
    v_exp_f32 v117, v117
    v_exp_f32 v118, v118
    v_exp_f32 v119, v119
    v_cvt_pk_bf16_f32 v146, v116, v117
    v_cvt_pk_bf16_f32 v147, v118, v119
    v_mfma_f32_32x32x16_bf16 v[96:111], v[200:203], v[152:155], v[96:111]
    v_exp_f32 v120, v120
    v_exp_f32 v121, v121
    v_exp_f32 v122, v122
    v_exp_f32 v123, v123
    v_cvt_pk_bf16_f32 v148, v120, v121
    v_cvt_pk_bf16_f32 v149, v122, v123
    v_mfma_f32_32x32x16_bf16 v[96:111], v[204:207], v[156:159], v[96:111]
    v_exp_f32 v124, v124
    v_exp_f32 v125, v125
    v_exp_f32 v126, v126
    v_exp_f32 v127, v127
    v_cvt_pk_bf16_f32 v150, v124, v125
    v_cvt_pk_bf16_f32 v151, v126, v127
    v_mfma_f32_32x32x16_bf16 v[112:127], v[160:163], v[32:35], 0
    buffer_load_dwordx4 v[196:199], v3, s[4:7], s46 offen offset:1024
    v_exp_f32 v128, v128
    v_exp_f32 v129, v129
    v_exp_f32 v130, v130
    v_exp_f32 v131, v131
    v_cvt_pk_bf16_f32 v152, v128, v129
    v_cvt_pk_bf16_f32 v153, v130, v131
    v_mfma_f32_32x32x16_bf16 v[112:127], v[164:167], v[36:39], v[112:127]
    s_waitcnt vmcnt(6)
    v_exp_f32 v132, v132
    v_exp_f32 v133, v133
    v_exp_f32 v134, v134
    v_exp_f32 v135, v135
    v_cvt_pk_bf16_f32 v154, v132, v133
    v_cvt_pk_bf16_f32 v155, v134, v135
    v_mfma_f32_32x32x16_bf16 v[48:63], v[168:171], v[144:147], v[48:63]
    v_exp_f32 v136, v136
    v_exp_f32 v137, v137
    v_exp_f32 v138, v138
    v_exp_f32 v139, v139
    v_cvt_pk_bf16_f32 v156, v136, v137
    v_cvt_pk_bf16_f32 v157, v138, v139
    v_mfma_f32_32x32x16_bf16 v[48:63], v[172:175], v[148:151], v[48:63]
    v_exp_f32 v140, v140
    v_exp_f32 v141, v141
    v_exp_f32 v142, v142
    v_exp_f32 v143, v143
    v_cvt_pk_bf16_f32 v158, v140, v141
    v_cvt_pk_bf16_f32 v159, v142, v143
    v_mfma_f32_32x32x16_bf16 v[128:143], v[160:163], v[40:43], 0
    buffer_load_dwordx4 v[200:203], v208, s[4:7], s46 offen offset:0
    v_exp_f32 v112, v112
    v_exp_f32 v113, v113
    v_exp_f32 v114, v114
    v_exp_f32 v115, v115
    v_cvt_pk_bf16_f32 v144, v112, v113
    v_cvt_pk_bf16_f32 v145, v114, v115
    v_mfma_f32_32x32x16_bf16 v[128:143], v[164:167], v[44:47], v[128:143]
    v_exp_f32 v116, v116
    v_exp_f32 v117, v117
    v_exp_f32 v118, v118
    v_exp_f32 v119, v119
    v_cvt_pk_bf16_f32 v146, v116, v117
    v_cvt_pk_bf16_f32 v147, v118, v119
    v_mfma_f32_32x32x16_bf16 v[64:79], v[168:171], v[152:155], v[64:79]
    v_exp_f32 v120, v120
    v_exp_f32 v121, v121
    v_exp_f32 v122, v122
    v_exp_f32 v123, v123
    v_cvt_pk_bf16_f32 v148, v120, v121
    v_cvt_pk_bf16_f32 v149, v122, v123
    v_mfma_f32_32x32x16_bf16 v[64:79], v[172:175], v[156:159], v[64:79]
    s_waitcnt vmcnt(5)
    v_exp_f32 v124, v124
    v_exp_f32 v125, v125
    v_exp_f32 v126, v126
    v_exp_f32 v127, v127
    v_cvt_pk_bf16_f32 v150, v124, v125
    v_cvt_pk_bf16_f32 v151, v126, v127
    v_mfma_f32_32x32x16_bf16 v[112:127], v[176:179], v[16:19], 0
    buffer_load_dwordx4 v[204:207], v216, s[4:7], s46 offen offset:0
    v_exp_f32 v128, v128
    v_exp_f32 v129, v129
    v_exp_f32 v130, v130
    v_exp_f32 v131, v131
    v_cvt_pk_bf16_f32 v152, v128, v129
    v_cvt_pk_bf16_f32 v153, v130, v131
    v_mfma_f32_32x32x16_bf16 v[112:127], v[180:183], v[20:23], v[112:127]
    v_exp_f32 v132, v132
    v_exp_f32 v133, v133
    v_exp_f32 v134, v134
    v_exp_f32 v135, v135
    v_cvt_pk_bf16_f32 v154, v132, v133
    v_cvt_pk_bf16_f32 v155, v134, v135
    v_mfma_f32_32x32x16_bf16 v[80:95], v[168:171], v[144:147], v[80:95]
    v_exp_f32 v136, v136
    v_exp_f32 v137, v137
    v_exp_f32 v138, v138
    v_exp_f32 v139, v139
    v_cvt_pk_bf16_f32 v156, v136, v137
    v_cvt_pk_bf16_f32 v157, v138, v139
    v_mfma_f32_32x32x16_bf16 v[80:95], v[172:175], v[148:151], v[80:95]
    v_exp_f32 v140, v140
    v_exp_f32 v141, v141
    v_exp_f32 v142, v142
    v_exp_f32 v143, v143
    v_cvt_pk_bf16_f32 v158, v140, v141
    v_cvt_pk_bf16_f32 v159, v142, v143
    v_mfma_f32_32x32x16_bf16 v[128:143], v[176:179], v[24:27], 0
    buffer_load_dwordx4 v[160:163], v3, s[4:7], s47 offen offset:0
    v_exp_f32 v112, v112
    v_exp_f32 v113, v113
    v_exp_f32 v114, v114
    v_exp_f32 v115, v115
    v_cvt_pk_bf16_f32 v144, v112, v113
    v_cvt_pk_bf16_f32 v145, v114, v115
    v_mfma_f32_32x32x16_bf16 v[128:143], v[180:183], v[28:31], v[128:143]
    v_exp_f32 v116, v116
    v_exp_f32 v117, v117
    v_exp_f32 v118, v118
    v_exp_f32 v119, v119
    v_cvt_pk_bf16_f32 v146, v116, v117
    v_cvt_pk_bf16_f32 v147, v118, v119
    v_mfma_f32_32x32x16_bf16 v[96:111], v[168:171], v[152:155], v[96:111]
    v_exp_f32 v120, v120
    v_exp_f32 v121, v121
    v_exp_f32 v122, v122
    v_exp_f32 v123, v123
    v_cvt_pk_bf16_f32 v148, v120, v121
    v_cvt_pk_bf16_f32 v149, v122, v123
    v_mfma_f32_32x32x16_bf16 v[96:111], v[172:175], v[156:159], v[96:111]
    v_exp_f32 v124, v124
    v_exp_f32 v125, v125
    v_exp_f32 v126, v126
    v_exp_f32 v127, v127
    v_cvt_pk_bf16_f32 v150, v124, v125
    v_cvt_pk_bf16_f32 v151, v126, v127
    v_mfma_f32_32x32x16_bf16 v[112:127], v[176:179], v[32:35], 0
    buffer_load_dwordx4 v[164:167], v3, s[4:7], s47 offen offset:1024
    v_exp_f32 v128, v128
    v_exp_f32 v129, v129
    v_exp_f32 v130, v130
    v_exp_f32 v131, v131
    v_cvt_pk_bf16_f32 v152, v128, v129
    v_cvt_pk_bf16_f32 v153, v130, v131
    v_mfma_f32_32x32x16_bf16 v[112:127], v[180:183], v[36:39], v[112:127]
    s_waitcnt vmcnt(6)
    v_exp_f32 v132, v132
    v_exp_f32 v133, v133
    v_exp_f32 v134, v134
    v_exp_f32 v135, v135
    v_cvt_pk_bf16_f32 v154, v132, v133
    v_cvt_pk_bf16_f32 v155, v134, v135
    v_mfma_f32_32x32x16_bf16 v[48:63], v[184:187], v[144:147], v[48:63]
    v_exp_f32 v136, v136
    v_exp_f32 v137, v137
    v_exp_f32 v138, v138
    v_exp_f32 v139, v139
    v_cvt_pk_bf16_f32 v156, v136, v137
    v_cvt_pk_bf16_f32 v157, v138, v139
    v_mfma_f32_32x32x16_bf16 v[48:63], v[188:191], v[148:151], v[48:63]
    v_exp_f32 v140, v140
    v_exp_f32 v141, v141
    v_exp_f32 v142, v142
    v_exp_f32 v143, v143
    v_cvt_pk_bf16_f32 v158, v140, v141
    v_cvt_pk_bf16_f32 v159, v142, v143
    v_mfma_f32_32x32x16_bf16 v[128:143], v[176:179], v[40:43], 0
    buffer_load_dwordx4 v[168:171], v208, s[4:7], s47 offen offset:0
    v_exp_f32 v112, v112
    v_exp_f32 v113, v113
    v_exp_f32 v114, v114
    v_exp_f32 v115, v115
    v_cvt_pk_bf16_f32 v144, v112, v113
    v_cvt_pk_bf16_f32 v145, v114, v115
    v_mfma_f32_32x32x16_bf16 v[128:143], v[180:183], v[44:47], v[128:143]
    v_exp_f32 v116, v116
    v_exp_f32 v117, v117
    v_exp_f32 v118, v118
    v_exp_f32 v119, v119
    v_cvt_pk_bf16_f32 v146, v116, v117
    v_cvt_pk_bf16_f32 v147, v118, v119
    v_mfma_f32_32x32x16_bf16 v[64:79], v[184:187], v[152:155], v[64:79]
    v_exp_f32 v120, v120
    v_exp_f32 v121, v121
    v_exp_f32 v122, v122
    v_exp_f32 v123, v123
    v_cvt_pk_bf16_f32 v148, v120, v121
    v_cvt_pk_bf16_f32 v149, v122, v123
    v_mfma_f32_32x32x16_bf16 v[64:79], v[188:191], v[156:159], v[64:79]
    s_waitcnt vmcnt(5)
    v_exp_f32 v124, v124
    v_exp_f32 v125, v125
    v_exp_f32 v126, v126
    v_exp_f32 v127, v127
    v_cvt_pk_bf16_f32 v150, v124, v125
    v_cvt_pk_bf16_f32 v151, v126, v127
    v_mfma_f32_32x32x16_bf16 v[112:127], v[192:195], v[16:19], 0
    buffer_load_dwordx4 v[172:175], v216, s[4:7], s47 offen offset:0
    v_exp_f32 v128, v128
    v_exp_f32 v129, v129
    v_exp_f32 v130, v130
    v_exp_f32 v131, v131
    v_cvt_pk_bf16_f32 v152, v128, v129
    v_cvt_pk_bf16_f32 v153, v130, v131
    v_mfma_f32_32x32x16_bf16 v[112:127], v[196:199], v[20:23], v[112:127]
    v_exp_f32 v132, v132
    v_exp_f32 v133, v133
    v_exp_f32 v134, v134
    v_exp_f32 v135, v135
    v_cvt_pk_bf16_f32 v154, v132, v133
    v_cvt_pk_bf16_f32 v155, v134, v135
    v_mfma_f32_32x32x16_bf16 v[80:95], v[184:187], v[144:147], v[80:95]
    v_exp_f32 v136, v136
    v_exp_f32 v137, v137
    v_exp_f32 v138, v138
    v_exp_f32 v139, v139
    v_cvt_pk_bf16_f32 v156, v136, v137
    v_cvt_pk_bf16_f32 v157, v138, v139
    v_mfma_f32_32x32x16_bf16 v[80:95], v[188:191], v[148:151], v[80:95]
    v_exp_f32 v140, v140
    v_exp_f32 v141, v141
    v_exp_f32 v142, v142
    v_exp_f32 v143, v143
    v_cvt_pk_bf16_f32 v158, v140, v141
    v_cvt_pk_bf16_f32 v159, v142, v143
    v_mfma_f32_32x32x16_bf16 v[128:143], v[192:195], v[24:27], 0
    v_exp_f32 v112, v112
    v_exp_f32 v113, v113
    v_exp_f32 v114, v114
    v_exp_f32 v115, v115
    v_cvt_pk_bf16_f32 v144, v112, v113
    v_cvt_pk_bf16_f32 v145, v114, v115
    v_mfma_f32_32x32x16_bf16 v[128:143], v[196:199], v[28:31], v[128:143]
    v_exp_f32 v116, v116
    v_exp_f32 v117, v117
    v_exp_f32 v118, v118
    v_exp_f32 v119, v119
    v_cvt_pk_bf16_f32 v146, v116, v117
    v_cvt_pk_bf16_f32 v147, v118, v119
    v_mfma_f32_32x32x16_bf16 v[96:111], v[184:187], v[152:155], v[96:111]
    v_exp_f32 v120, v120
    v_exp_f32 v121, v121
    v_exp_f32 v122, v122
    v_exp_f32 v123, v123
    v_cvt_pk_bf16_f32 v148, v120, v121
    v_cvt_pk_bf16_f32 v149, v122, v123
    v_mfma_f32_32x32x16_bf16 v[96:111], v[188:191], v[156:159], v[96:111]
    v_exp_f32 v124, v124
    v_exp_f32 v125, v125
    v_exp_f32 v126, v126
    v_exp_f32 v127, v127
    v_cvt_pk_bf16_f32 v150, v124, v125
    v_cvt_pk_bf16_f32 v151, v126, v127
    v_mfma_f32_32x32x16_bf16 v[112:127], v[192:195], v[32:35], 0
    v_exp_f32 v128, v128
    v_exp_f32 v129, v129
    v_exp_f32 v130, v130
    v_exp_f32 v131, v131
    v_cvt_pk_bf16_f32 v152, v128, v129
    v_cvt_pk_bf16_f32 v153, v130, v131
    v_mfma_f32_32x32x16_bf16 v[112:127], v[196:199], v[36:39], v[112:127]
    s_waitcnt vmcnt(4)
    v_exp_f32 v132, v132
    v_exp_f32 v133, v133
    v_exp_f32 v134, v134
    v_exp_f32 v135, v135
    v_cvt_pk_bf16_f32 v154, v132, v133
    v_cvt_pk_bf16_f32 v155, v134, v135
    v_mfma_f32_32x32x16_bf16 v[48:63], v[200:203], v[144:147], v[48:63]
    v_exp_f32 v136, v136
    v_exp_f32 v137, v137
    v_exp_f32 v138, v138
    v_exp_f32 v139, v139
    v_cvt_pk_bf16_f32 v156, v136, v137
    v_cvt_pk_bf16_f32 v157, v138, v139
    v_mfma_f32_32x32x16_bf16 v[48:63], v[204:207], v[148:151], v[48:63]
    v_exp_f32 v140, v140
    v_exp_f32 v141, v141
    v_exp_f32 v142, v142
    v_exp_f32 v143, v143
    v_cvt_pk_bf16_f32 v158, v140, v141
    v_cvt_pk_bf16_f32 v159, v142, v143
    v_mfma_f32_32x32x16_bf16 v[128:143], v[192:195], v[40:43], 0
    v_exp_f32 v112, v112
    v_exp_f32 v113, v113
    v_exp_f32 v114, v114
    v_exp_f32 v115, v115
    v_cvt_pk_bf16_f32 v144, v112, v113
    v_cvt_pk_bf16_f32 v145, v114, v115
    v_mfma_f32_32x32x16_bf16 v[128:143], v[196:199], v[44:47], v[128:143]
    v_exp_f32 v116, v116
    v_exp_f32 v117, v117
    v_exp_f32 v118, v118
    v_exp_f32 v119, v119
    v_cvt_pk_bf16_f32 v146, v116, v117
    v_cvt_pk_bf16_f32 v147, v118, v119
    v_mfma_f32_32x32x16_bf16 v[64:79], v[200:203], v[152:155], v[64:79]
    v_exp_f32 v120, v120
    v_exp_f32 v121, v121
    v_exp_f32 v122, v122
    v_exp_f32 v123, v123
    v_cvt_pk_bf16_f32 v148, v120, v121
    v_cvt_pk_bf16_f32 v149, v122, v123
    v_mfma_f32_32x32x16_bf16 v[64:79], v[204:207], v[156:159], v[64:79]
    s_waitcnt vmcnt(2)
    v_exp_f32 v124, v124
    v_exp_f32 v125, v125
    v_exp_f32 v126, v126
    v_exp_f32 v127, v127
    v_cvt_pk_bf16_f32 v150, v124, v125
    v_cvt_pk_bf16_f32 v151, v126, v127
    v_mfma_f32_32x32x16_bf16 v[112:127], v[160:163], v[24:27], 0
    v_exp_f32 v128, v128
    v_exp_f32 v129, v129
    v_exp_f32 v130, v130
    v_exp_f32 v131, v131
    v_cvt_pk_bf16_f32 v152, v128, v129
    v_cvt_pk_bf16_f32 v153, v130, v131
    v_mfma_f32_32x32x16_bf16 v[112:127], v[164:167], v[28:31], v[112:127]
    v_exp_f32 v132, v132
    v_exp_f32 v133, v133
    v_exp_f32 v134, v134
    v_exp_f32 v135, v135
    v_cvt_pk_bf16_f32 v154, v132, v133
    v_cvt_pk_bf16_f32 v155, v134, v135
    v_mfma_f32_32x32x16_bf16 v[80:95], v[200:203], v[144:147], v[80:95]
    v_exp_f32 v136, v136
    v_exp_f32 v137, v137
    v_exp_f32 v138, v138
    v_exp_f32 v139, v139
    v_cvt_pk_bf16_f32 v156, v136, v137
    v_cvt_pk_bf16_f32 v157, v138, v139
    v_mfma_f32_32x32x16_bf16 v[80:95], v[204:207], v[148:151], v[80:95]
    v_exp_f32 v140, v140
    v_exp_f32 v141, v141
    v_exp_f32 v142, v142
    v_exp_f32 v143, v143
    v_cvt_pk_bf16_f32 v158, v140, v141
    v_cvt_pk_bf16_f32 v159, v142, v143
    v_mfma_f32_32x32x16_bf16 v[128:143], v[160:163], v[32:35], 0
    v_exp_f32 v112, v112
    v_exp_f32 v113, v113
    v_exp_f32 v114, v114
    v_exp_f32 v115, v115
    v_cvt_pk_bf16_f32 v144, v112, v113
    v_cvt_pk_bf16_f32 v145, v114, v115
    v_mfma_f32_32x32x16_bf16 v[128:143], v[164:167], v[36:39], v[128:143]
    v_exp_f32 v116, v116
    v_exp_f32 v117, v117
    v_exp_f32 v118, v118
    v_exp_f32 v119, v119
    v_cvt_pk_bf16_f32 v146, v116, v117
    v_cvt_pk_bf16_f32 v147, v118, v119
    v_mfma_f32_32x32x16_bf16 v[96:111], v[200:203], v[152:155], v[96:111]
    v_exp_f32 v120, v120
    v_exp_f32 v121, v121
    v_exp_f32 v122, v122
    v_exp_f32 v123, v123
    v_cvt_pk_bf16_f32 v148, v120, v121
    v_cvt_pk_bf16_f32 v149, v122, v123
    v_mfma_f32_32x32x16_bf16 v[96:111], v[204:207], v[156:159], v[96:111]
    v_exp_f32 v124, v124
    v_exp_f32 v125, v125
    v_exp_f32 v126, v126
    v_exp_f32 v127, v127
    v_cvt_pk_bf16_f32 v150, v124, v125
    v_cvt_pk_bf16_f32 v151, v126, v127
    v_mfma_f32_32x32x16_bf16 v[112:127], v[160:163], v[40:43], 0
    v_exp_f32 v128, v128
    v_exp_f32 v129, v129
    v_exp_f32 v130, v130
    v_exp_f32 v131, v131
    v_cvt_pk_bf16_f32 v152, v128, v129
    v_cvt_pk_bf16_f32 v153, v130, v131
    v_mfma_f32_32x32x16_bf16 v[112:127], v[164:167], v[44:47], v[112:127]
    s_waitcnt vmcnt(0)
    v_exp_f32 v132, v132
    v_exp_f32 v133, v133
    v_exp_f32 v134, v134
    v_exp_f32 v135, v135
    v_cvt_pk_bf16_f32 v154, v132, v133
    v_cvt_pk_bf16_f32 v155, v134, v135
    v_mfma_f32_32x32x16_bf16 v[64:79], v[168:171], v[144:147], v[64:79]
    v_exp_f32 v136, v136
    v_exp_f32 v137, v137
    v_exp_f32 v138, v138
    v_exp_f32 v139, v139
    v_cvt_pk_bf16_f32 v156, v136, v137
    v_cvt_pk_bf16_f32 v157, v138, v139
    v_mfma_f32_32x32x16_bf16 v[64:79], v[172:175], v[148:151], v[64:79]
    v_exp_f32 v140, v140
    v_exp_f32 v141, v141
    v_exp_f32 v142, v142
    v_exp_f32 v143, v143
    v_cvt_pk_bf16_f32 v158, v140, v141
    v_cvt_pk_bf16_f32 v159, v142, v143
    v_mfma_f32_32x32x16_bf16 v[128:143], v[160:163], v[16:19], 0
    v_exp_f32 v112, v112
    v_exp_f32 v113, v113
    v_exp_f32 v114, v114
    v_exp_f32 v115, v115
    v_cvt_pk_bf16_f32 v144, v112, v113
    v_cvt_pk_bf16_f32 v145, v114, v115
    v_mfma_f32_32x32x16_bf16 v[128:143], v[164:167], v[20:23], v[128:143]
    ds_write_b128 v5, v[64:67] offset:0
    ds_write_b128 v5, v[68:71] offset:1024
    v_exp_f32 v116, v116
    v_exp_f32 v117, v117
    v_exp_f32 v118, v118
    v_exp_f32 v119, v119
    v_cvt_pk_bf16_f32 v146, v116, v117
    v_cvt_pk_bf16_f32 v147, v118, v119
    v_mfma_f32_32x32x16_bf16 v[80:95], v[168:171], v[152:155], v[80:95]
    ds_write_b128 v5, v[72:75] offset:2048
    v_exp_f32 v120, v120
    v_exp_f32 v121, v121
    v_exp_f32 v122, v122
    v_exp_f32 v123, v123
    v_cvt_pk_bf16_f32 v148, v120, v121
    v_cvt_pk_bf16_f32 v149, v122, v123
    v_mfma_f32_32x32x16_bf16 v[80:95], v[172:175], v[156:159], v[80:95]
    ds_write_b128 v5, v[76:79] offset:3072
    v_exp_f32 v124, v124
    v_exp_f32 v125, v125
    v_exp_f32 v126, v126
    v_exp_f32 v127, v127
    v_cvt_pk_bf16_f32 v150, v124, v125
    v_cvt_pk_bf16_f32 v151, v126, v127
    v_exp_f32 v128, v128
    v_exp_f32 v129, v129
    v_exp_f32 v130, v130
    v_exp_f32 v131, v131
    v_cvt_pk_bf16_f32 v152, v128, v129
    v_cvt_pk_bf16_f32 v153, v130, v131
    ds_write_b128 v6, v[80:83] offset:4096
    ds_write_b128 v6, v[84:87] offset:5120
    v_exp_f32 v132, v132
    v_exp_f32 v133, v133
    v_exp_f32 v134, v134
    v_exp_f32 v135, v135
    v_cvt_pk_bf16_f32 v154, v132, v133
    v_cvt_pk_bf16_f32 v155, v134, v135
    v_mfma_f32_32x32x16_bf16 v[96:111], v[168:171], v[144:147], v[96:111]
    ds_write_b128 v6, v[88:91] offset:6144
    v_exp_f32 v136, v136
    v_exp_f32 v137, v137
    v_exp_f32 v138, v138
    v_exp_f32 v139, v139
    v_cvt_pk_bf16_f32 v156, v136, v137
    v_cvt_pk_bf16_f32 v157, v138, v139
    v_mfma_f32_32x32x16_bf16 v[96:111], v[172:175], v[148:151], v[96:111]
    ds_write_b128 v6, v[92:95] offset:7168
    v_exp_f32 v140, v140
    v_exp_f32 v141, v141
    v_exp_f32 v142, v142
    v_exp_f32 v143, v143
    v_cvt_pk_bf16_f32 v158, v140, v141
    v_cvt_pk_bf16_f32 v159, v142, v143
    v_mfma_f32_32x32x16_bf16 v[48:63], v[168:171], v[152:155], v[48:63]
    s_nop 0
    v_mfma_f32_32x32x16_bf16 v[48:63], v[172:175], v[156:159], v[48:63]
    s_nop 1
    ds_write_b128 v7, v[96:99] offset:8192
    ds_write_b128 v7, v[100:103] offset:9216
    ds_write_b128 v7, v[104:107] offset:10240
    ds_write_b128 v7, v[108:111] offset:11264
    s_waitcnt lgkmcnt(0)
    s_barrier
    ds_read_b128 v[112:115], v4 offset:0
    ds_read_b128 v[116:119], v4 offset:1024
    ds_read_b128 v[120:123], v4 offset:2048
    ds_read_b128 v[124:127], v4 offset:3072
    ds_read_b128 v[128:131], v4 offset:4096
    ds_read_b128 v[132:135], v4 offset:5120
    ds_read_b128 v[136:139], v4 offset:6144
    ds_read_b128 v[140:143], v4 offset:7168
    ds_read_b128 v[144:147], v4 offset:8192
    ds_read_b128 v[148:151], v4 offset:9216
    ds_read_b128 v[152:155], v4 offset:10240
    ds_read_b128 v[156:159], v4 offset:11264
    s_waitcnt lgkmcnt(8)
    v_add_f32 v48, v48, v112
    v_add_f32 v49, v49, v113
    v_add_f32 v50, v50, v114
    v_add_f32 v51, v51, v115
    v_add_f32 v52, v52, v116
    v_add_f32 v53, v53, v117
    v_add_f32 v54, v54, v118
    v_add_f32 v55, v55, v119
    v_add_f32 v56, v56, v120
    v_add_f32 v57, v57, v121
    v_add_f32 v58, v58, v122
    v_add_f32 v59, v59, v123
    v_add_f32 v60, v60, v124
    v_add_f32 v61, v61, v125
    v_add_f32 v62, v62, v126
    s_waitcnt lgkmcnt(4)
    v_add_f32 v48, v48, v128
    v_add_f32 v49, v49, v129
    v_add_f32 v50, v50, v130
    v_add_f32 v51, v51, v131
    v_add_f32 v52, v52, v132
    v_add_f32 v53, v53, v133
    v_add_f32 v54, v54, v134
    v_add_f32 v55, v55, v135
    v_add_f32 v56, v56, v136
    v_add_f32 v57, v57, v137
    v_add_f32 v58, v58, v138
    v_add_f32 v59, v59, v139
    v_add_f32 v60, v60, v140
    v_add_f32 v61, v61, v141
    v_add_f32 v62, v62, v142
    s_waitcnt lgkmcnt(0)
    v_add_f32 v48, v48, v144
    v_add_f32 v49, v49, v145
    v_add_f32 v50, v50, v146
    v_add_f32 v51, v51, v147
    v_add_f32 v52, v52, v148
    v_add_f32 v53, v53, v149
    v_add_f32 v54, v54, v150
    v_add_f32 v55, v55, v151
    v_add_f32 v56, v56, v152
    v_add_f32 v57, v57, v153
    v_add_f32 v58, v58, v154
    v_add_f32 v59, v59, v155
    v_add_f32 v60, v60, v156
    v_add_f32 v61, v61, v157
    v_add_f32 v62, v62, v158
    v_cmp_lt_f32 vcc, 0x2b800000, v55
    s_mov_b32 s23, 0x53800000
    v_cmp_gt_f32 s[60:61], s23, v55
    s_nop 1
    s_and_b64 vcc, vcc, s[60:61]
    s_cmp_eq_u64 vcc, -1
    s_cbranch_scc0 Lfallback_14
Lnorm_13:
    v_rcp_f32 v9, v55
    s_nop 0
    v_mul_f32 v48, v48, v9
    v_mul_f32 v49, v49, v9
    v_mul_f32 v50, v50, v9
    v_mul_f32 v51, v51, v9
    v_mul_f32 v52, v52, v9
    v_mul_f32 v53, v53, v9
    v_mul_f32 v54, v54, v9
    v_cvt_pk_bf16_f32 v112, v48, v49
    v_cvt_pk_bf16_f32 v113, v50, v51
    v_cvt_pk_bf16_f32 v114, v52, v53
    v_cvt_pk_bf16_f32 v115, v54, v217
    buffer_store_dwordx4 v[112:115], v2, s[4:7], s28 offen offset:0 sc1
    v_mul_f32 v56, v56, v9
    v_mul_f32 v57, v57, v9
    v_mul_f32 v58, v58, v9
    v_mul_f32 v59, v59, v9
    v_mul_f32 v60, v60, v9
    v_mul_f32 v61, v61, v9
    v_mul_f32 v62, v62, v9
    v_cvt_pk_bf16_f32 v116, v56, v57
    v_cvt_pk_bf16_f32 v117, v58, v59
    v_cvt_pk_bf16_f32 v118, v60, v61
    v_cvt_pk_bf16_f32 v119, v62, v217
    buffer_store_dwordx4 v[116:119], v2, s[4:7], s28 offen offset:1024 sc1
    s_mov_b64 exec, 0xffff
    buffer_store_dwordx2 v[14:15], v218, s[4:7], s29 offen sc1
    s_mov_b64 exec, -1
    s_endpgm
Lfallback_14:
    v_mov_b32 v11, 0xff800000
    s_mov_b32 s23, s25
    s_mov_b32 s24, 64
Lfb1_15:
    buffer_load_dwordx4 v[160:163], v3, s[4:7], s23 offen offset:0
    buffer_load_dwordx4 v[164:167], v3, s[4:7], s23 offen offset:1024
    s_waitcnt vmcnt(0)
    v_mfma_f32_32x32x16_bf16 v[112:127], v[160:163], v[16:19], 0
    v_mfma_f32_32x32x16_bf16 v[112:127], v[164:167], v[20:23], v[112:127]
    s_nop 11
    v_max3_f32 v11, v112, v113, v11
    v_max3_f32 v11, v114, v115, v11
    v_max3_f32 v11, v116, v117, v11
    v_max3_f32 v11, v118, v119, v11
    v_max3_f32 v11, v120, v121, v11
    v_max3_f32 v11, v122, v123, v11
    v_max3_f32 v11, v124, v125, v11
    v_max3_f32 v11, v126, v127, v11
    s_add_u32 s23, s23, 59392
    s_sub_u32 s24, s24, 1
    s_cmp_lg_u32 s24, 0
    s_cbranch_scc1 Lfb1_15
    v_mov_b32 v8, v11
    v_mov_b32 v9, v11
    s_nop 1
    v_permlane32_swap_b32 v8, v9
    v_max_f32 v11, v8, v9
    v_mov_b32 v48, 0
    v_mov_b32 v49, 0
    v_mov_b32 v50, 0
    v_mov_b32 v51, 0
    v_mov_b32 v52, 0
    v_mov_b32 v53, 0
    v_mov_b32 v54, 0
    v_mov_b32 v55, 0
    v_mov_b32 v56, 0
    v_mov_b32 v57, 0
    v_mov_b32 v58, 0
    v_mov_b32 v59, 0
    v_mov_b32 v60, 0
    v_mov_b32 v61, 0
    v_mov_b32 v62, 0
    v_mov_b32 v63, 0
    s_mov_b32 s23, s25
    s_mov_b32 s24, 64
Lfb2_16:
    buffer_load_dwordx4 v[160:163], v3, s[4:7], s23 offen offset:0
    buffer_load_dwordx4 v[164:167], v3, s[4:7], s23 offen offset:1024
    buffer_load_dwordx4 v[168:171], v208, s[4:7], s23 offen offset:0
    buffer_load_dwordx4 v[172:175], v216, s[4:7], s23 offen offset:0
    s_waitcnt vmcnt(0)
    v_mfma_f32_32x32x16_bf16 v[112:127], v[160:163], v[16:19], 0
    v_mfma_f32_32x32x16_bf16 v[112:127], v[164:167], v[20:23], v[112:127]
    s_nop 11
    v_sub_f32 v112, v112, v11
    v_sub_f32 v113, v113, v11
    v_sub_f32 v114, v114, v11
    v_sub_f32 v115, v115, v11
    v_sub_f32 v116, v116, v11
    v_sub_f32 v117, v117, v11
    v_sub_f32 v118, v118, v11
    v_sub_f32 v119, v119, v11
    v_sub_f32 v120, v120, v11
    v_sub_f32 v121, v121, v11
    v_sub_f32 v122, v122, v11
    v_sub_f32 v123, v123, v11
    v_sub_f32 v124, v124, v11
    v_sub_f32 v125, v125, v11
    v_sub_f32 v126, v126, v11
    v_sub_f32 v127, v127, v11
    v_exp_f32 v112, v112
    v_exp_f32 v113, v113
    v_exp_f32 v114, v114
    v_exp_f32 v115, v115
    v_exp_f32 v116, v116
    v_exp_f32 v117, v117
    v_exp_f32 v118, v118
    v_exp_f32 v119, v119
    v_exp_f32 v120, v120
    v_exp_f32 v121, v121
    v_exp_f32 v122, v122
    v_exp_f32 v123, v123
    v_exp_f32 v124, v124
    v_exp_f32 v125, v125
    v_exp_f32 v126, v126
    v_exp_f32 v127, v127
    v_cvt_pk_bf16_f32 v144, v112, v113
    v_cvt_pk_bf16_f32 v145, v114, v115
    v_cvt_pk_bf16_f32 v146, v116, v117
    v_cvt_pk_bf16_f32 v147, v118, v119
    v_cvt_pk_bf16_f32 v148, v120, v121
    v_cvt_pk_bf16_f32 v149, v122, v123
    v_cvt_pk_bf16_f32 v150, v124, v125
    v_cvt_pk_bf16_f32 v151, v126, v127
    v_mfma_f32_32x32x16_bf16 v[48:63], v[168:171], v[144:147], v[48:63]
    s_nop 0
    v_mfma_f32_32x32x16_bf16 v[48:63], v[172:175], v[148:151], v[48:63]
    s_add_u32 s23, s23, 59392
    s_sub_u32 s24, s24, 1
    s_cmp_lg_u32 s24, 0
    s_nop 11
    s_cbranch_scc1 Lfb2_16
    s_branch Lnorm_13
Lgate_3:
    s_load_dwordx2 s[46:47], s[0:1], 96
    s_load_dwordx2 s[32:33], s[0:1], 16
    s_memrealtime s[24:25]
    s_and_b32 s20, s2, 3
    s_lshl_b32 s20, s20, 3
    s_and_b32 s21, s2, 4
    s_add_u32 s20, s20, s21
    s_bfe_u32 s21, s2, 0x20003
    s_add_u32 s20, s20, s21
    s_mul_i32 s21, s20, 57344
    v_lshrrev_b32 v6, 2, v0
    v_and_b32 v2, 3, v0
    v_lshlrev_b32 v2, 4, v2
    v_mul_u32_u24 v3, 896, v6
    v_add_u32 v3, v3, v2
    v_mov_b32 v7, 0
    s_waitcnt lgkmcnt(0)
    s_mov_b32 s10, s60
    s_mov_b32 s11, s61
    s_or_b32 s22, s20, s3
    s_cmp_lg_u32 s22, 0
    s_cbranch_scc1 Lnolead_17
    s_or_b32 s24, s24, 1
    s_mov_b64 exec, 1
    v_mov_b32 v4, s24
    v_mov_b32 v5, s25
    global_store_dwordx2 v7, v[4:5], s[10:11] sc1
    s_mov_b64 exec, -1
Lnolead_17:
    s_mov_b32 s12, s8
    s_and_b32 s13, s9, 0xffff
    s_mov_b32 s14, 1835008
    s_mov_b32 s15, 0x20000
    s_mov_b32 s16, s46
    s_and_b32 s17, s47, 0xffff
    s_mov_b32 s18, 896
    s_mov_b32 s19, 0x20000
    s_mov_b32 s4, s62
    s_and_b32 s5, s63, 0xffff
    s_mov_b32 s6, 18350080
    s_mov_b32 s7, 0x20000
    buffer_load_dwordx4 v[16:19], v3, s[12:15], s21 offen offset:0
    buffer_load_dwordx4 v[20:23], v2, s[16:19], 0 offen offset:0
    buffer_load_dwordx4 v[24:27], v3, s[12:15], s21 offen offset:64
    buffer_load_dwordx4 v[28:31], v2, s[16:19], 0 offen offset:64
    buffer_load_dwordx4 v[32:35], v3, s[12:15], s21 offen offset:128
    buffer_load_dwordx4 v[36:39], v2, s[16:19], 0 offen offset:128
    buffer_load_dwordx4 v[40:43], v3, s[12:15], s21 offen offset:192
    buffer_load_dwordx4 v[44:47], v2, s[16:19], 0 offen offset:192
    buffer_load_dwordx4 v[48:51], v3, s[12:15], s21 offen offset:256
    buffer_load_dwordx4 v[52:55], v2, s[16:19], 0 offen offset:256
    buffer_load_dwordx4 v[56:59], v3, s[12:15], s21 offen offset:320
    buffer_load_dwordx4 v[60:63], v2, s[16:19], 0 offen offset:320
    buffer_load_dwordx4 v[64:67], v3, s[12:15], s21 offen offset:384
    buffer_load_dwordx4 v[68:71], v2, s[16:19], 0 offen offset:384
    buffer_load_dwordx4 v[72:75], v3, s[12:15], s21 offen offset:448
    buffer_load_dwordx4 v[76:79], v2, s[16:19], 0 offen offset:448
    buffer_load_dwordx4 v[80:83], v3, s[12:15], s21 offen offset:512
    buffer_load_dwordx4 v[84:87], v2, s[16:19], 0 offen offset:512
    buffer_load_dwordx4 v[88:91], v3, s[12:15], s21 offen offset:576
    buffer_load_dwordx4 v[92:95], v2, s[16:19], 0 offen offset:576
    buffer_load_dwordx4 v[96:99], v3, s[12:15], s21 offen offset:640
    buffer_load_dwordx4 v[100:103], v2, s[16:19], 0 offen offset:640
    buffer_load_dwordx4 v[104:107], v3, s[12:15], s21 offen offset:704
    buffer_load_dwordx4 v[108:111], v2, s[16:19], 0 offen offset:704
    buffer_load_dwordx4 v[112:115], v3, s[12:15], s21 offen offset:768
    buffer_load_dwordx4 v[116:119], v2, s[16:19], 0 offen offset:768
    buffer_load_dwordx4 v[120:123], v3, s[12:15], s21 offen offset:832
    buffer_load_dwordx4 v[124:127], v2, s[16:19], 0 offen offset:832
    global_load_dwordx2 v[4:5], v7, s[10:11] sc1
    v_mov_b32 v8, 0
    v_mov_b32 v9, 0
    v_mov_b32 v10, 0
    v_mov_b32 v11, 0
    s_waitcnt vmcnt(27)
    v_dot2_f32_bf16 v8, v16, v20, v8
    v_dot2_f32_bf16 v9, v17, v21, v9
    v_dot2_f32_bf16 v10, v18, v22, v10
    v_dot2_f32_bf16 v11, v19, v23, v11
    s_waitcnt vmcnt(25)
    v_dot2_f32_bf16 v8, v24, v28, v8
    v_dot2_f32_bf16 v9, v25, v29, v9
    v_dot2_f32_bf16 v10, v26, v30, v10
    v_dot2_f32_bf16 v11, v27, v31, v11
    s_waitcnt vmcnt(23)
    v_dot2_f32_bf16 v8, v32, v36, v8
    v_dot2_f32_bf16 v9, v33, v37, v9
    v_dot2_f32_bf16 v10, v34, v38, v10
    v_dot2_f32_bf16 v11, v35, v39, v11
    s_waitcnt vmcnt(21)
    v_dot2_f32_bf16 v8, v40, v44, v8
    v_dot2_f32_bf16 v9, v41, v45, v9
    v_dot2_f32_bf16 v10, v42, v46, v10
    v_dot2_f32_bf16 v11, v43, v47, v11
    s_waitcnt vmcnt(19)
    v_dot2_f32_bf16 v8, v48, v52, v8
    v_dot2_f32_bf16 v9, v49, v53, v9
    v_dot2_f32_bf16 v10, v50, v54, v10
    v_dot2_f32_bf16 v11, v51, v55, v11
    s_waitcnt vmcnt(17)
    v_dot2_f32_bf16 v8, v56, v60, v8
    v_dot2_f32_bf16 v9, v57, v61, v9
    v_dot2_f32_bf16 v10, v58, v62, v10
    v_dot2_f32_bf16 v11, v59, v63, v11
    s_waitcnt vmcnt(15)
    v_dot2_f32_bf16 v8, v64, v68, v8
    v_dot2_f32_bf16 v9, v65, v69, v9
    v_dot2_f32_bf16 v10, v66, v70, v10
    v_dot2_f32_bf16 v11, v67, v71, v11
    s_waitcnt vmcnt(13)
    v_dot2_f32_bf16 v8, v72, v76, v8
    v_dot2_f32_bf16 v9, v73, v77, v9
    v_dot2_f32_bf16 v10, v74, v78, v10
    v_dot2_f32_bf16 v11, v75, v79, v11
    s_waitcnt vmcnt(11)
    v_dot2_f32_bf16 v8, v80, v84, v8
    v_dot2_f32_bf16 v9, v81, v85, v9
    v_dot2_f32_bf16 v10, v82, v86, v10
    v_dot2_f32_bf16 v11, v83, v87, v11
    s_waitcnt vmcnt(9)
    v_dot2_f32_bf16 v8, v88, v92, v8
    v_dot2_f32_bf16 v9, v89, v93, v9
    v_dot2_f32_bf16 v10, v90, v94, v10
    v_dot2_f32_bf16 v11, v91, v95, v11
    s_waitcnt vmcnt(7)
    v_dot2_f32_bf16 v8, v96, v100, v8
    v_dot2_f32_bf16 v9, v97, v101, v9
    v_dot2_f32_bf16 v10, v98, v102, v10
    v_dot2_f32_bf16 v11, v99, v103, v11
    s_waitcnt vmcnt(5)
    v_dot2_f32_bf16 v8, v104, v108, v8
    v_dot2_f32_bf16 v9, v105, v109, v9
    v_dot2_f32_bf16 v10, v106, v110, v10
    v_dot2_f32_bf16 v11, v107, v111, v11
    s_waitcnt vmcnt(3)
    v_dot2_f32_bf16 v8, v112, v116, v8
    v_dot2_f32_bf16 v9, v113, v117, v9
    v_dot2_f32_bf16 v10, v114, v118, v10
    v_dot2_f32_bf16 v11, v115, v119, v11
    s_waitcnt vmcnt(1)
    v_dot2_f32_bf16 v8, v120, v124, v8
    v_dot2_f32_bf16 v9, v121, v125, v9
    v_dot2_f32_bf16 v10, v122, v126, v10
    v_dot2_f32_bf16 v11, v123, v127, v11
    s_nop 3
    v_add_f32 v8, v8, v9
    v_add_f32 v10, v10, v11
    v_add_f32 v8, v8, v10
    s_nop 1
    v_add_f32_dpp v8, v8, v8 quad_perm:[1,0,3,2] row_mask:0xf bank_mask:0xf
    s_nop 1
    v_add_f32_dpp v8, v8, v8 quad_perm:[2,3,0,1] row_mask:0xf bank_mask:0xf
    v_mul_f32 v8, 0xbfb8aa3b, v8
    v_exp_f32 v8, v8
    s_nop 0
    v_add_f32 v8, 1.0, v8
    v_rcp_f32 v8, v8
    s_lshl_b32 s21, s20, 8
    s_add_u32 s21, s21, 12582912
    v_lshlrev_b32 v6, 2, v6
    buffer_store_dword v8, v6, s[4:7], s21 offen sc1
    s_waitcnt vmcnt(1)
    s_mov_b32 s22, 2097152
Ltag_18:
    v_readfirstlane_b32 s8, v4
    v_readfirstlane_b32 s9, v5
    s_nop 0
    s_cmp_lg_u32 s8, 0
    s_cbranch_scc1 Ltagd_19
    s_sub_u32 s22, s22, 1
    s_cbranch_scc1 Ltagd_19
    global_load_dwordx2 v[4:5], v7, s[10:11] sc1
    s_waitcnt vmcnt(0)
    s_branch Ltag_18
Ltagd_19:
    s_getreg_b32 s22, hwreg(HW_REG_XCC_ID, 0, 3)
    s_getreg_b32 s23, hwreg(HW_REG_HW_ID, 8, 8)
    s_lshl_b32 s22, s22, 8
    s_or_b32 s22, s22, s23
    s_lshl_b32 s22, s22, 7
    s_add_u32 s22, s22, 18087936
    s_mov_b64 exec, 1
    buffer_store_dwordx2 v[4:5], v7, s[4:7], s22 offen
    s_mov_b64 exec, -1
    s_and_b32 s33, s33, 0xffff
    s_mov_b32 s34, 401408
    s_mov_b32 s35, 0x20000
    s_bfe_u32 s22, s2, 0x20003
    s_lshl_b32 s22, s22, 15
    v_lshlrev_b32 v9, 7, v0
    s_add_u32 s23, s22, 0
    buffer_load_dword v140, v9, s[32:35], s23 offen
    s_add_u32 s23, s22, 131072
    buffer_load_dword v141, v9, s[32:35], s23 offen
    s_add_u32 s23, s22, 262144
    buffer_load_dword v142, v9, s[32:35], s23 offen
    s_add_u32 s23, s22, 393216
    buffer_load_dword v143, v9, s[32:35], s23 offen
    s_lshl_b32 s20, s20, 3
    s_add_u32 s20, s20, 204800
    v_mov_b32 v211, s20
    s_mov_b64 s[26:27], 1
    s_branch Lattn_4
LS_1:
    s_load_dwordx2 s[40:41], s[0:1], 16
    s_load_dwordx2 s[44:45], s[0:1], 104
    s_mov_b32 s4, s62
    s_and_b32 s5, s63, 0xffff
    s_mov_b32 s6, 18350080
    s_mov_b32 s7, 0x20000
    s_mov_b32 s10, s60
    s_mov_b32 s11, s61
    s_mul_i32 s21, s52, 14
    s_add_u32 s21, s21, s53
    s_lshl_b32 s21, s21, 11
    s_add_u32 s21, s21, 6291456
    s_add_u32 s22, s55, s52
    s_lshl_b32 s22, s22, 3
    s_add_u32 s22, s22, 17858560
    v_and_b32 v30, 31, v1
    v_lshrrev_b32 v31, 5, v1
    v_bfe_u32 v32, v1, 2, 2
    v_bfe_u32 v33, v1, 4, 1
    v_lshlrev_b32 v34, 3, v29
    v_lshl_add_u32 v34, v33, 5, v34
    v_lshl_add_u32 v35, v31, 3, v32
    v_lshl_add_u32 v35, v35, 6, v34
    v_add_u32 v21, s20, v35
    v_lshlrev_b32 v35, 5, v30
    v_lshl_add_u32 v7, v31, 4, v35
    v_mov_b32 v16, 0
    v_lshlrev_b32 v2, 4, v1
    v_lshlrev_b32 v23, 3, v1
    v_mul_u32_u24 v35, 528, v30
    v_lshl_add_u32 v35, v31, 4, v35
    v_add_u32 v15, s20, v35
    s_lshl_b32 s52, s14, 13
    s_add_u32 s52, s52, s20
    v_add_u32 v3, s52, v2
    s_xor_b32 s52, s3, 1
    s_mul_i32 s53, s52, 16896
    s_and_b32 s52, s52, 1
    s_lshl_b32 s52, s52, 13
    s_add_u32 s52, s52, s53
    v_add_u32 v4, s52, v2
    s_mul_i32 s38, s31, 33792
    s_add_u32 s38, s38, 4096
    s_mul_i32 s55, s31, 7680
    s_add_u32 s55, s55, 65024
    s_lshl_b32 s24, s14, 11
    s_add_u32 s24, s24, s55
    s_add_u32 s24, s24, 2560
    s_mul_i32 s37, s14, 1280
    s_add_u32 s37, s37, s55
    s_lshr_b32 s52, s13, 5
    s_lshl_b32 s23, s52, 9
    s_add_u32 s23, s23, 17858560
    s_lshl_b32 s25, s52, 11
    s_and_b32 s52, s13, 31
    s_lshl_b32 s52, s52, 5
    s_add_u32 s25, s25, s52
    s_add_u32 s25, s25, 6291456
    s_lshl_b32 s52, s14, 7
    v_add_u32 v35, s52, v1
    v_add_u32 v36, 0, v35
    v_mul_u32_u24 v37, 13108, v36
    v_lshrrev_b32 v37, 16, v37
    v_mul_u32_u24 v38, 5, v37
    v_sub_u32 v36, v36, v38
    v_and_b32 v36, 3, v36
    v_mul_u32_u24 v37, 28672, v37
    v_lshrrev_b32 v38, 1, v36
    v_lshl_add_u32 v37, v38, 10, v37
    v_and_b32 v38, 1, v36
    v_lshl_add_u32 v248, v38, 4, v37
    v_add_u32 v36, 64, v35
    v_mul_u32_u24 v37, 13108, v36
    v_lshrrev_b32 v37, 16, v37
    v_mul_u32_u24 v38, 5, v37
    v_sub_u32 v36, v36, v38
    v_and_b32 v36, 3, v36
    v_mul_u32_u24 v37, 28672, v37
    v_lshrrev_b32 v38, 1, v36
    v_lshl_add_u32 v37, v38, 10, v37
    v_and_b32 v38, 1, v36
    v_lshl_add_u32 v249, v38, 4, v37
    v_add_u32 v36, 128, v35
    v_mul_u32_u24 v37, 13108, v36
    v_lshrrev_b32 v37, 16, v37
    v_mul_u32_u24 v38, 5, v37
    v_sub_u32 v36, v36, v38
    v_and_b32 v36, 3, v36
    v_mul_u32_u24 v37, 28672, v37
    v_lshrrev_b32 v38, 1, v36
    v_lshl_add_u32 v37, v38, 10, v37
    v_and_b32 v38, 1, v36
    v_lshl_add_u32 v250, v38, 4, v37
    v_sub_u32 v35, 31, v30
    v_lshlrev_b32 v35, 4, v35
    v_add_u32 v35, s38, v35
    v_lshl_add_u32 v6, v31, 10, v35
    v_lshlrev_b32 v36, 9, v31
    v_sub_u32 v35, v35, v36
    v_add_u32 v5, 512, v35
    v_sub_u32 v35, 3, v29
    v_mul_u32_u24 v35, 4160, v35
    v_lshrrev_b32 v36, 2, v30
    v_lshlrev_b32 v36, 3, v36
    v_sub_u32 v35, v35, v36
    v_lshl_add_u32 v35, v31, 4, v35
    s_lshl_b32 s52, s14, 5
    s_add_u32 s53, s52, s38
    s_add_u32 s53, s53, 56
    v_add_u32 v14, s53, v35
    v_mul_u32_u24 v35, 80, v30
    v_lshl_add_u32 v35, v31, 4, v35
    s_add_u32 s53, s52, s55
    s_add_u32 s53, s53, 80
    v_add_u32 v22, s53, v35
    s_lshl_b32 s26, s13, 12
    s_lshl_b32 s52, s14, 11
    s_add_u32 s26, s26, s52
    s_add_u32 s26, s26, 15728640
    s_mul_i32 s27, s14, 448
    s_add_u32 s27, s27, s13
    s_lshl_b32 s27, s27, 3
    s_add_u32 s27, s27, 18022400
    s_and_b32 s52, s12, 7
    s_lshl_b32 s52, s52, 2
    s_bfe_u32 s53, s12, 0x20003
    s_add_u32 s52, s52, s53
    s_lshr_b32 s53, s12, 5
    s_lshl_b32 s28, s52, 1
    s_add_u32 s28, s28, s14
    s_lshl_b32 s29, s53, 1
    s_add_u32 s29, s29, s31
    s_lshl_b32 s29, s29, 5
    s_lshl_b32 s36, s28, 1
    s_add_u32 s36, s36, s31
    s_lshl_b32 s30, s36, 14
    s_add_u32 s30, s30, 13631488
    s_mul_i32 s36, s36, 1024
    s_add_u32 s36, s36, 17891328
    v_lshrrev_b32 v35, 3, v1
    v_mul_u32_u24 v35, 896, v35
    v_and_b32 v36, 7, v1
    v_lshlrev_b32 v37, 2, v33
    v_xor_b32 v36, v36, v37
    v_lshl_add_u32 v35, v36, 4, v35
    s_mul_i32 s54, s3, 7168
    s_lshl_b32 s53, s53, 7
    s_add_u32 s54, s54, s53
    v_add_u32 v251, s54, v35
    s_lshl_b32 s32, s3, 10
    v_mad_u32_u24 v36, v31, 7, v32
    v_lshl_add_u32 v35, v36, 7, v34
    v_bfe_u32 v36, v36, 1, 1
    v_xor_b32 v36, s31, v36
    v_lshl_add_u32 v35, v36, 6, v35
    s_mul_i32 s54, s31, 28672
    v_add_u32 v252, s54, v35
    v_mul_u32_u24 v35, 896, v30
    v_lshl_add_u32 v255, v31, 4, v35
    s_mul_i32 s33, s28, 28672
    s_lshl_b32 s54, s29, 1
    s_add_u32 s33, s33, s54
    s_lshr_b32 s54, s28, 5
    s_mul_i32 s53, s54, 448
    s_add_u32 s53, s53, s29
    v_add_u32 v35, s53, v1
    s_add_u32 s53, s52, 1024
    v_mov_b32 v36, s53
    v_cmp_gt_u32 vcc, 32, v1
    s_nop 1
    v_cndmask_b32 v35, v36, v35, vcc
    v_lshlrev_b32 v254, 3, v35
    v_add_u32 v35, s29, v30
    v_lshlrev_b32 v35, 12, v35
    v_lshl_add_u32 v253, v31, 4, v35
    s_lshl_b32 s34, s54, 11
    s_and_b32 s53, s28, 31
    s_lshl_b32 s53, s53, 5
    s_add_u32 s34, s34, s53
    s_add_u32 s34, s34, 15728640
    s_lshl_b32 s35, s28, 7
    s_add_u32 s35, s35, 12582912
    v_and_b32 v35, 1, v1
    v_cmp_eq_u32 s[56:57], 1, v35
    s_waitcnt lgkmcnt(0)
    s_and_b32 s41, s41, 0xffff
    s_mov_b32 s42, 401408
    s_mov_b32 s43, 0x20000
    s_and_b32 s45, s45, 0xffff
    s_mov_b32 s46, 1835008
    s_mov_b32 s47, 0x20000
    s_waitcnt vmcnt(9)
    v_lshlrev_b32 v26, 16, v24
    v_mov_b32 v29, 0x3fb8aa3b
    v_mul_f32 v27, v26, v29
    v_fma_f32 v28, v26, v29, -v27
    v_fmac_f32 v28, 0x32a57060, v26
    v_exp_f32 v27, v27
    v_mul_f32 v28, 0x3f317218, v28
    v_fmac_f32 v27, v27, v28
    v_cvt_pk_bf16_f32 v17, v27, v27
    v_lshlrev_b32 v17, 16, v17
    s_waitcnt vmcnt(2)
    v_lshlrev_b32 v25, 16, v25
    v_lshlrev_b32 v32, 16, v8
    v_and_b32 v40, 0xffff0000, v8
    v_lshlrev_b32 v33, 16, v9
    v_and_b32 v41, 0xffff0000, v9
    v_lshlrev_b32 v34, 16, v10
    v_and_b32 v42, 0xffff0000, v10
    v_lshlrev_b32 v35, 16, v11
    v_and_b32 v43, 0xffff0000, v11
    v_lshlrev_b32 v36, 16, v12
    v_and_b32 v44, 0xffff0000, v12
    v_lshlrev_b32 v37, 16, v13
    v_and_b32 v45, 0xffff0000, v13
    v_mul_f32 v32, v17, v32
    v_mul_f32 v40, v17, v40
    v_mul_f32 v33, v17, v33
    v_mul_f32 v41, v17, v41
    v_mul_f32 v34, v17, v34
    v_mul_f32 v42, v17, v42
    v_mul_f32 v35, v17, v35
    v_mul_f32 v43, v17, v43
    v_mul_f32 v32, 0x3fb8aa3b, v32
    v_mul_f32 v40, 0x3fb8aa3b, v40
    v_mul_f32 v33, 0x3e22f983, v33
    v_mul_f32 v41, 0x3e22f983, v41
    v_mul_f32 v48, 0x41000000, v32
    v_mul_f32 v52, 0x41000000, v40
    v_mul_f32 v49, 0x41000000, v33
    v_mul_f32 v53, 0x41000000, v41
    v_exp_f32 v48, v48
    v_exp_f32 v52, v52
    v_fract_f32 v49, v49
    v_fract_f32 v53, v53
    v_cos_f32 v50, v49
    v_cos_f32 v54, v53
    v_sin_f32 v51, v49
    v_sin_f32 v55, v53
    v_mul_f32 v186, v48, v50
    v_mul_f32 v212, v52, v54
    v_mul_f32 v187, v48, v51
    v_mul_f32 v213, v52, v55
    v_exp_f32 v48, v32
    v_exp_f32 v52, v40
    v_fract_f32 v49, v33
    v_fract_f32 v53, v41
    v_cos_f32 v50, v49
    v_cos_f32 v54, v53
    v_sin_f32 v51, v49
    v_sin_f32 v55, v53
    v_mul_f32 v184, v48, v50
    v_mul_f32 v210, v52, v54
    v_mul_f32 v185, v48, v51
    v_mul_f32 v211, v52, v55
    v_mul_f32 v48, 0x43800000, v32
    v_mul_f32 v52, 0x43800000, v40
    v_mul_f32 v49, 0x43800000, v33
    v_mul_f32 v53, 0x43800000, v41
    v_exp_f32 v48, v48
    v_exp_f32 v52, v52
    v_fract_f32 v49, v49
    v_fract_f32 v53, v53
    v_cos_f32 v50, v49
    v_cos_f32 v54, v53
    v_sin_f32 v51, v49
    v_sin_f32 v55, v53
    v_mul_f32 v188, v48, v50
    v_mul_f32 v214, v52, v54
    v_mul_f32 v189, v48, v51
    v_mul_f32 v215, v52, v55
    v_mov_b32 v64, 0x3f80
    v_mov_b32 v65, 0x3f80
    v_mul_f32 v26, v35, v37
    v_mul_f32 v27, v34, v37
    v_mul_f32 v28, v43, v45
    v_mul_f32 v29, v42, v45
    v_fma_f32 v190, v34, v36, -v26
    v_fma_f32 v191, v35, v36, v27
    v_fma_f32 v216, v42, v44, -v28
    v_fma_f32 v217, v43, v44, v29
    v_cvt_pk_bf16_f32 v128, v190, -v191
    v_cvt_pk_bf16_f32 v129, v216, -v217
    v_mul_f32 v30, v187, v187
    v_mul_f32 v31, v186, v187
    v_mul_f32 v26, v213, v213
    v_mul_f32 v27, v212, v213
    v_cvt_pk_bf16_f32 v66, v186, v187
    v_cvt_pk_bf16_f32 v67, v212, v213
    v_fma_f32 v196, v186, v186, -v30
    v_fma_f32 v197, v187, v186, v31
    v_fma_f32 v222, v212, v212, -v26
    v_fma_f32 v223, v213, v212, v27
    v_mul_f32 v28, v191, v185
    v_mul_f32 v29, v190, v185
    v_mul_f32 v30, v217, v211
    v_mul_f32 v31, v216, v211
    v_cvt_pk_bf16_f32 v68, v196, v197
    v_cvt_pk_bf16_f32 v69, v222, v223
    v_fma_f32 v206, v190, v184, -v28
    v_fma_f32 v207, v191, v184, v29
    v_fma_f32 v232, v216, v210, -v30
    v_fma_f32 v233, v217, v210, v31
    v_mul_f32 v26, v197, v187
    v_mul_f32 v27, v196, v187
    v_mul_f32 v28, v223, v213
    v_mul_f32 v29, v222, v213
    v_cvt_pk_bf16_f32 v130, v206, -v207
    v_cvt_pk_bf16_f32 v131, v232, -v233
    v_fma_f32 v194, v196, v186, -v26
    v_fma_f32 v195, v197, v186, v27
    v_fma_f32 v220, v222, v212, -v28
    v_fma_f32 v221, v223, v212, v29
    v_mul_f32 v30, v207, v185
    v_mul_f32 v31, v206, v185
    v_mul_f32 v26, v233, v211
    v_mul_f32 v27, v232, v211
    v_cvt_pk_bf16_f32 v70, v194, v195
    v_cvt_pk_bf16_f32 v71, v220, v221
    v_fma_f32 v198, v206, v184, -v30
    v_fma_f32 v199, v207, v184, v31
    v_fma_f32 v224, v232, v210, -v26
    v_fma_f32 v225, v233, v210, v27
    v_mul_f32 v28, v197, v197
    v_mul_f32 v29, v196, v197
    v_mul_f32 v30, v223, v223
    v_mul_f32 v31, v222, v223
    v_cvt_pk_bf16_f32 v132, v198, -v199
    v_cvt_pk_bf16_f32 v133, v224, -v225
    v_fma_f32 v192, v196, v196, -v28
    v_fma_f32 v193, v197, v196, v29
    v_fma_f32 v218, v222, v222, -v30
    v_fma_f32 v219, v223, v222, v31
    v_mul_f32 v26, v199, v185
    v_mul_f32 v27, v198, v185
    v_mul_f32 v28, v225, v211
    v_mul_f32 v29, v224, v211
    v_cvt_pk_bf16_f32 v72, v192, v193
    v_cvt_pk_bf16_f32 v73, v218, v219
    v_fma_f32 v206, v198, v184, -v26
    v_fma_f32 v207, v199, v184, v27
    v_fma_f32 v232, v224, v210, -v28
    v_fma_f32 v233, v225, v210, v29
    v_mul_f32 v30, v195, v197
    v_mul_f32 v31, v194, v197
    v_mul_f32 v26, v221, v223
    v_mul_f32 v27, v220, v223
    v_cvt_pk_bf16_f32 v134, v206, -v207
    v_cvt_pk_bf16_f32 v135, v232, -v233
    v_fma_f32 v194, v194, v196, -v30
    v_fma_f32 v195, v195, v196, v31
    v_fma_f32 v220, v220, v222, -v26
    v_fma_f32 v221, v221, v222, v27
    v_mul_f32 v28, v207, v185
    v_mul_f32 v29, v206, v185
    v_mul_f32 v30, v233, v211
    v_mul_f32 v31, v232, v211
    v_cvt_pk_bf16_f32 v74, v194, v195
    v_cvt_pk_bf16_f32 v75, v220, v221
    v_fma_f32 v200, v206, v184, -v28
    v_fma_f32 v201, v207, v184, v29
    v_fma_f32 v226, v232, v210, -v30
    v_fma_f32 v227, v233, v210, v31
    v_mul_f32 v26, v193, v197
    v_mul_f32 v27, v192, v197
    v_mul_f32 v28, v219, v223
    v_mul_f32 v29, v218, v223
    v_cvt_pk_bf16_f32 v136, v200, -v201
    v_cvt_pk_bf16_f32 v137, v226, -v227
    v_fma_f32 v192, v192, v196, -v26
    v_fma_f32 v193, v193, v196, v27
    v_fma_f32 v218, v218, v222, -v28
    v_fma_f32 v219, v219, v222, v29
    v_mul_f32 v30, v201, v185
    v_mul_f32 v31, v200, v185
    v_mul_f32 v26, v227, v211
    v_mul_f32 v27, v226, v211
    v_cvt_pk_bf16_f32 v76, v192, v193
    v_cvt_pk_bf16_f32 v77, v218, v219
    v_fma_f32 v206, v200, v184, -v30
    v_fma_f32 v207, v201, v184, v31
    v_fma_f32 v232, v226, v210, -v26
    v_fma_f32 v233, v227, v210, v27
    v_mul_f32 v28, v195, v197
    v_mul_f32 v29, v194, v197
    v_mul_f32 v30, v221, v223
    v_mul_f32 v31, v220, v223
    v_cvt_pk_bf16_f32 v138, v206, -v207
    v_cvt_pk_bf16_f32 v139, v232, -v233
    v_fma_f32 v194, v194, v196, -v28
    v_fma_f32 v195, v195, v196, v29
    v_fma_f32 v220, v220, v222, -v30
    v_fma_f32 v221, v221, v222, v31
    v_mul_f32 v26, v207, v185
    v_mul_f32 v27, v206, v185
    v_mul_f32 v28, v233, v211
    v_mul_f32 v29, v232, v211
    v_cvt_pk_bf16_f32 v78, v194, v195
    v_cvt_pk_bf16_f32 v79, v220, v221
    v_fma_f32 v202, v206, v184, -v26
    v_fma_f32 v203, v207, v184, v27
    v_fma_f32 v228, v232, v210, -v28
    v_fma_f32 v229, v233, v210, v29
    v_mul_f32 v30, v193, v197
    v_mul_f32 v31, v192, v197
    v_mul_f32 v26, v219, v223
    v_mul_f32 v27, v218, v223
    v_cvt_pk_bf16_f32 v140, v202, -v203
    v_cvt_pk_bf16_f32 v141, v228, -v229
    v_fma_f32 v192, v192, v196, -v30
    v_fma_f32 v193, v193, v196, v31
    v_fma_f32 v218, v218, v222, -v26
    v_fma_f32 v219, v219, v222, v27
    v_mul_f32 v28, v203, v185
    v_mul_f32 v29, v202, v185
    v_mul_f32 v30, v229, v211
    v_mul_f32 v31, v228, v211
    v_cvt_pk_bf16_f32 v80, v192, v193
    v_cvt_pk_bf16_f32 v81, v218, v219
    v_fma_f32 v206, v202, v184, -v28
    v_fma_f32 v207, v203, v184, v29
    v_fma_f32 v232, v228, v210, -v30
    v_fma_f32 v233, v229, v210, v31
    v_mul_f32 v26, v195, v197
    v_mul_f32 v27, v194, v197
    v_mul_f32 v28, v221, v223
    v_mul_f32 v29, v220, v223
    v_cvt_pk_bf16_f32 v142, v206, -v207
    v_cvt_pk_bf16_f32 v143, v232, -v233
    v_fma_f32 v194, v194, v196, -v26
    v_fma_f32 v195, v195, v196, v27
    v_fma_f32 v220, v220, v222, -v28
    v_fma_f32 v221, v221, v222, v29
    v_mul_f32 v30, v191, v187
    v_mul_f32 v31, v190, v187
    v_mul_f32 v26, v217, v213
    v_mul_f32 v27, v216, v213
    v_cvt_pk_bf16_f32 v82, v194, v195
    v_cvt_pk_bf16_f32 v83, v220, v221
    v_fma_f32 v204, v190, v186, -v30
    v_fma_f32 v205, v191, v186, v31
    v_fma_f32 v230, v216, v212, -v26
    v_fma_f32 v231, v217, v212, v27
    v_mul_f32 v28, v193, v197
    v_mul_f32 v29, v192, v197
    v_mul_f32 v30, v219, v223
    v_mul_f32 v31, v218, v223
    v_cvt_pk_bf16_f32 v144, v204, -v205
    v_cvt_pk_bf16_f32 v145, v230, -v231
    v_fma_f32 v192, v192, v196, -v28
    v_fma_f32 v193, v193, v196, v29
    v_fma_f32 v218, v218, v222, -v30
    v_fma_f32 v219, v219, v222, v31
    v_mul_f32 v26, v191, v189
    v_mul_f32 v27, v190, v189
    v_mul_f32 v28, v217, v215
    v_mul_f32 v29, v216, v215
    v_cvt_pk_bf16_f32 v84, v192, v193
    v_cvt_pk_bf16_f32 v85, v218, v219
    v_fma_f32 v208, v190, v188, -v26
    v_fma_f32 v209, v191, v188, v27
    v_fma_f32 v234, v216, v214, -v28
    v_fma_f32 v235, v217, v214, v29
    v_mul_f32 v30, v195, v197
    v_mul_f32 v31, v194, v197
    v_mul_f32 v26, v221, v223
    v_mul_f32 v27, v220, v223
    v_cvt_pk_bf16_f32 v146, v208, -v209
    v_cvt_pk_bf16_f32 v147, v234, -v235
    v_fma_f32 v194, v194, v196, -v30
    v_fma_f32 v195, v195, v196, v31
    v_fma_f32 v220, v220, v222, -v26
    v_fma_f32 v221, v221, v222, v27
    v_mul_f32 v28, v199, v189
    v_mul_f32 v29, v198, v189
    v_mul_f32 v30, v225, v215
    v_mul_f32 v31, v224, v215
    v_cvt_pk_bf16_f32 v86, v194, v195
    v_cvt_pk_bf16_f32 v87, v220, v221
    v_fma_f32 v198, v198, v188, -v28
    v_fma_f32 v199, v199, v188, v29
    v_fma_f32 v224, v224, v214, -v30
    v_fma_f32 v225, v225, v214, v31
    v_mul_f32 v26, v193, v197
    v_mul_f32 v27, v192, v197
    v_mul_f32 v28, v219, v223
    v_mul_f32 v29, v218, v223
    v_cvt_pk_bf16_f32 v148, v198, -v199
    v_cvt_pk_bf16_f32 v149, v224, -v225
    v_fma_f32 v192, v192, v196, -v26
    v_fma_f32 v193, v193, v196, v27
    v_fma_f32 v218, v218, v222, -v28
    v_fma_f32 v219, v219, v222, v29
    v_mul_f32 v30, v201, v189
    v_mul_f32 v31, v200, v189
    v_mul_f32 v26, v227, v215
    v_mul_f32 v27, v226, v215
    v_cvt_pk_bf16_f32 v88, v192, v193
    v_cvt_pk_bf16_f32 v89, v218, v219
    v_fma_f32 v200, v200, v188, -v30
    v_fma_f32 v201, v201, v188, v31
    v_fma_f32 v226, v226, v214, -v26
    v_fma_f32 v227, v227, v214, v27
    v_mul_f32 v28, v195, v197
    v_mul_f32 v29, v194, v197
    v_mul_f32 v30, v221, v223
    v_mul_f32 v31, v220, v223
    v_cvt_pk_bf16_f32 v150, v200, -v201
    v_cvt_pk_bf16_f32 v151, v226, -v227
    v_fma_f32 v194, v194, v196, -v28
    v_fma_f32 v195, v195, v196, v29
    v_fma_f32 v220, v220, v222, -v30
    v_fma_f32 v221, v221, v222, v31
    v_mul_f32 v26, v203, v189
    v_mul_f32 v27, v202, v189
    v_mul_f32 v28, v229, v215
    v_mul_f32 v29, v228, v215
    v_cvt_pk_bf16_f32 v90, v194, v195
    v_cvt_pk_bf16_f32 v91, v220, v221
    v_fma_f32 v202, v202, v188, -v26
    v_fma_f32 v203, v203, v188, v27
    v_fma_f32 v228, v228, v214, -v28
    v_fma_f32 v229, v229, v214, v29
    v_mul_f32 v30, v193, v197
    v_mul_f32 v31, v192, v197
    v_mul_f32 v26, v219, v223
    v_mul_f32 v27, v218, v223
    v_cvt_pk_bf16_f32 v152, v202, -v203
    v_cvt_pk_bf16_f32 v153, v228, -v229
    v_fma_f32 v192, v192, v196, -v30
    v_fma_f32 v193, v193, v196, v31
    v_fma_f32 v218, v218, v222, -v26
    v_fma_f32 v219, v219, v222, v27
    v_mul_f32 v28, v205, v189
    v_mul_f32 v29, v204, v189
    v_mul_f32 v30, v231, v215
    v_mul_f32 v31, v230, v215
    v_cvt_pk_bf16_f32 v92, v192, v193
    v_cvt_pk_bf16_f32 v93, v218, v219
    v_fma_f32 v204, v204, v188, -v28
    v_fma_f32 v205, v205, v188, v29
    v_fma_f32 v230, v230, v214, -v30
    v_fma_f32 v231, v231, v214, v31
    v_mul_f32 v26, v195, v197
    v_mul_f32 v27, v194, v197
    v_mul_f32 v28, v221, v223
    v_mul_f32 v29, v220, v223
    v_cvt_pk_bf16_f32 v154, v204, -v205
    v_cvt_pk_bf16_f32 v155, v230, -v231
    v_fma_f32 v194, v194, v196, -v26
    v_fma_f32 v195, v195, v196, v27
    v_fma_f32 v220, v220, v222, -v28
    v_fma_f32 v221, v221, v222, v29
    v_mul_f32 v30, v209, v189
    v_mul_f32 v31, v208, v189
    v_mul_f32 v26, v235, v215
    v_mul_f32 v27, v234, v215
    v_cvt_pk_bf16_f32 v94, v194, v195
    v_cvt_pk_bf16_f32 v95, v220, v221
    v_fma_f32 v208, v208, v188, -v30
    v_fma_f32 v209, v209, v188, v31
    v_fma_f32 v234, v234, v214, -v26
    v_fma_f32 v235, v235, v214, v27
    v_mul_f32 v28, v193, v197
    v_mul_f32 v29, v192, v197
    v_mul_f32 v30, v219, v223
    v_mul_f32 v31, v218, v223
    v_cvt_pk_bf16_f32 v156, v208, -v209
    v_cvt_pk_bf16_f32 v157, v234, -v235
    v_fma_f32 v192, v192, v196, -v28
    v_fma_f32 v193, v193, v196, v29
    v_fma_f32 v218, v218, v222, -v30
    v_fma_f32 v219, v219, v222, v31
    v_mul_f32 v26, v201, v189
    v_mul_f32 v27, v200, v189
    v_mul_f32 v28, v227, v215
    v_mul_f32 v29, v226, v215
    v_cvt_pk_bf16_f32 v96, v192, v193
    v_cvt_pk_bf16_f32 v97, v218, v219
    v_fma_f32 v200, v200, v188, -v26
    v_fma_f32 v201, v201, v188, v27
    v_fma_f32 v226, v226, v214, -v28
    v_fma_f32 v227, v227, v214, v29
    v_mul_f32 v30, v195, v197
    v_mul_f32 v31, v194, v197
    v_mul_f32 v26, v221, v223
    v_mul_f32 v27, v220, v223
    v_cvt_pk_bf16_f32 v158, v200, -v201
    v_cvt_pk_bf16_f32 v159, v226, -v227
    v_fma_f32 v194, v194, v196, -v30
    v_fma_f32 v195, v195, v196, v31
    v_fma_f32 v220, v220, v222, -v26
    v_fma_f32 v221, v221, v222, v27
    v_mul_f32 v28, v205, v189
    v_mul_f32 v29, v204, v189
    v_mul_f32 v30, v231, v215
    v_mul_f32 v31, v230, v215
    v_cvt_pk_bf16_f32 v98, v194, v195
    v_cvt_pk_bf16_f32 v99, v220, v221
    v_fma_f32 v204, v204, v188, -v28
    v_fma_f32 v205, v205, v188, v29
    v_fma_f32 v230, v230, v214, -v30
    v_fma_f32 v231, v231, v214, v31
    v_mul_f32 v26, v193, v197
    v_mul_f32 v27, v192, v197
    v_mul_f32 v28, v219, v223
    v_mul_f32 v29, v218, v223
    v_cvt_pk_bf16_f32 v160, v204, -v205
    v_cvt_pk_bf16_f32 v161, v230, -v231
    v_fma_f32 v192, v192, v196, -v26
    v_fma_f32 v193, v193, v196, v27
    v_fma_f32 v218, v218, v222, -v28
    v_fma_f32 v219, v219, v222, v29
    v_mul_f32 v30, v209, v189
    v_mul_f32 v31, v208, v189
    v_mul_f32 v26, v235, v215
    v_mul_f32 v27, v234, v215
    v_cvt_pk_bf16_f32 v100, v192, v193
    v_cvt_pk_bf16_f32 v101, v218, v219
    v_fma_f32 v208, v208, v188, -v30
    v_fma_f32 v209, v209, v188, v31
    v_fma_f32 v234, v234, v214, -v26
    v_fma_f32 v235, v235, v214, v27
    v_mul_f32 v28, v195, v197
    v_mul_f32 v29, v194, v197
    v_mul_f32 v30, v221, v223
    v_mul_f32 v31, v220, v223
    v_cvt_pk_bf16_f32 v162, v208, -v209
    v_cvt_pk_bf16_f32 v163, v234, -v235
    v_fma_f32 v194, v194, v196, -v28
    v_fma_f32 v195, v195, v196, v29
    v_fma_f32 v220, v220, v222, -v30
    v_fma_f32 v221, v221, v222, v31
    s_waitcnt vmcnt(0)
    ds_read_b64_tr_b16 v[56:57], v21 offset:0
    ds_read_b64_tr_b16 v[58:59], v21 offset:256
    ds_read_b64_tr_b16 v[60:61], v21 offset:1024
    ds_read_b64_tr_b16 v[62:63], v21 offset:1280
    v_mul_f32 v26, v201, v189
    v_mul_f32 v27, v200, v189
    v_mul_f32 v28, v227, v215
    v_mul_f32 v29, v226, v215
    v_cvt_pk_bf16_f32 v102, v194, v195
    v_cvt_pk_bf16_f32 v103, v220, v221
    v_fma_f32 v200, v200, v188, -v26
    v_fma_f32 v201, v201, v188, v27
    v_fma_f32 v226, v226, v214, -v28
    v_fma_f32 v227, v227, v214, v29
    v_mul_f32 v30, v193, v197
    v_mul_f32 v31, v192, v197
    v_mul_f32 v26, v219, v223
    v_mul_f32 v27, v218, v223
    v_cvt_pk_bf16_f32 v164, v200, -v201
    v_cvt_pk_bf16_f32 v165, v226, -v227
    v_fma_f32 v192, v192, v196, -v30
    v_fma_f32 v193, v193, v196, v31
    v_fma_f32 v218, v218, v222, -v26
    v_fma_f32 v219, v219, v222, v27
    v_mul_f32 v28, v205, v189
    v_mul_f32 v29, v204, v189
    v_mul_f32 v30, v231, v215
    v_mul_f32 v31, v230, v215
    v_cvt_pk_bf16_f32 v104, v192, v193
    v_cvt_pk_bf16_f32 v105, v218, v219
    v_fma_f32 v204, v204, v188, -v28
    v_fma_f32 v205, v205, v188, v29
    v_fma_f32 v230, v230, v214, -v30
    v_fma_f32 v231, v231, v214, v31
    s_waitcnt lgkmcnt(0)
    buffer_store_dwordx4 v[56:59], v7, s[4:7], s21 offen offset:0 sc1
    buffer_store_dwordx4 v[60:63], v7, s[4:7], s21 offen offset:1024 sc1
    global_load_dwordx2 v[18:19], v16, s[10:11] sc1
    v_mul_f32 v26, v195, v197
    v_mul_f32 v27, v194, v197
    v_mul_f32 v28, v221, v223
    v_mul_f32 v29, v220, v223
    v_cvt_pk_bf16_f32 v166, v204, -v205
    v_cvt_pk_bf16_f32 v167, v230, -v231
    v_fma_f32 v194, v194, v196, -v26
    v_fma_f32 v195, v195, v196, v27
    v_fma_f32 v220, v220, v222, -v28
    v_fma_f32 v221, v221, v222, v29
    v_mul_f32 v30, v209, v189
    v_mul_f32 v31, v208, v189
    v_mul_f32 v26, v235, v215
    v_mul_f32 v27, v234, v215
    v_cvt_pk_bf16_f32 v106, v194, v195
    v_cvt_pk_bf16_f32 v107, v220, v221
    v_fma_f32 v208, v208, v188, -v30
    v_fma_f32 v209, v209, v188, v31
    v_fma_f32 v234, v234, v214, -v26
    v_fma_f32 v235, v235, v214, v27
    v_mul_f32 v28, v193, v197
    v_mul_f32 v29, v192, v197
    v_mul_f32 v30, v219, v223
    v_mul_f32 v31, v218, v223
    v_cvt_pk_bf16_f32 v168, v208, -v209
    v_cvt_pk_bf16_f32 v169, v234, -v235
    v_fma_f32 v192, v192, v196, -v28
    v_fma_f32 v193, v193, v196, v29
    v_fma_f32 v218, v218, v222, -v30
    v_fma_f32 v219, v219, v222, v31
    v_mul_f32 v26, v205, v189
    v_mul_f32 v27, v204, v189
    v_mul_f32 v28, v231, v215
    v_mul_f32 v29, v230, v215
    v_cvt_pk_bf16_f32 v108, v192, v193
    v_cvt_pk_bf16_f32 v109, v218, v219
    v_fma_f32 v204, v204, v188, -v26
    v_fma_f32 v205, v205, v188, v27
    v_fma_f32 v230, v230, v214, -v28
    v_fma_f32 v231, v231, v214, v29
    v_mul_f32 v30, v195, v197
    v_mul_f32 v31, v194, v197
    v_mul_f32 v26, v221, v223
    v_mul_f32 v27, v220, v223
    v_cvt_pk_bf16_f32 v170, v204, -v205
    v_cvt_pk_bf16_f32 v171, v230, -v231
    v_fma_f32 v194, v194, v196, -v30
    v_fma_f32 v195, v195, v196, v31
    v_fma_f32 v220, v220, v222, -v26
    v_fma_f32 v221, v221, v222, v27
    v_mul_f32 v28, v209, v189
    v_mul_f32 v29, v208, v189
    v_mul_f32 v30, v235, v215
    v_mul_f32 v31, v234, v215
    v_cvt_pk_bf16_f32 v110, v194, v195
    v_cvt_pk_bf16_f32 v111, v220, v221
    v_fma_f32 v208, v208, v188, -v28
    v_fma_f32 v209, v209, v188, v29
    v_fma_f32 v234, v234, v214, -v30
    v_fma_f32 v235, v235, v214, v31
    v_mul_f32 v26, v193, v197
    v_mul_f32 v27, v192, v197
    v_mul_f32 v28, v219, v223
    v_mul_f32 v29, v218, v223
    v_cvt_pk_bf16_f32 v172, v208, -v209
    v_cvt_pk_bf16_f32 v173, v234, -v235
    v_fma_f32 v192, v192, v196, -v26
    v_fma_f32 v193, v193, v196, v27
    v_fma_f32 v218, v218, v222, -v28
    v_fma_f32 v219, v219, v222, v29
    v_mul_f32 v30, v205, v189
    v_mul_f32 v31, v204, v189
    v_mul_f32 v26, v231, v215
    v_mul_f32 v27, v230, v215
    v_cvt_pk_bf16_f32 v112, v192, v193
    v_cvt_pk_bf16_f32 v113, v218, v219
    v_fma_f32 v204, v204, v188, -v30
    v_fma_f32 v205, v205, v188, v31
    v_fma_f32 v230, v230, v214, -v26
    v_fma_f32 v231, v231, v214, v27
    v_mul_f32 v28, v195, v197
    v_mul_f32 v29, v194, v197
    v_mul_f32 v30, v221, v223
    v_mul_f32 v31, v220, v223
    v_cvt_pk_bf16_f32 v174, v204, -v205
    v_cvt_pk_bf16_f32 v175, v230, -v231
    v_fma_f32 v194, v194, v196, -v28
    v_fma_f32 v195, v195, v196, v29
    v_fma_f32 v220, v220, v222, -v30
    v_fma_f32 v221, v221, v222, v31
    v_mul_f32 v26, v209, v189
    v_mul_f32 v27, v208, v189
    v_mul_f32 v28, v235, v215
    v_mul_f32 v29, v234, v215
    v_cvt_pk_bf16_f32 v114, v194, v195
    v_cvt_pk_bf16_f32 v115, v220, v221
    v_fma_f32 v208, v208, v188, -v26
    v_fma_f32 v209, v209, v188, v27
    v_fma_f32 v234, v234, v214, -v28
    v_fma_f32 v235, v235, v214, v29
    v_mul_f32 v30, v193, v197
    v_mul_f32 v31, v192, v197
    v_mul_f32 v26, v219, v223
    v_mul_f32 v27, v218, v223
    v_cvt_pk_bf16_f32 v176, v208, -v209
    v_cvt_pk_bf16_f32 v177, v234, -v235
    v_fma_f32 v192, v192, v196, -v30
    v_fma_f32 v193, v193, v196, v31
    v_fma_f32 v218, v218, v222, -v26
    v_fma_f32 v219, v219, v222, v27
    v_mul_f32 v28, v205, v189
    v_mul_f32 v29, v204, v189
    v_mul_f32 v30, v231, v215
    v_mul_f32 v31, v230, v215
    v_cvt_pk_bf16_f32 v116, v192, v193
    v_cvt_pk_bf16_f32 v117, v218, v219
    v_fma_f32 v204, v204, v188, -v28
    v_fma_f32 v205, v205, v188, v29
    v_fma_f32 v230, v230, v214, -v30
    v_fma_f32 v231, v231, v214, v31
    v_mul_f32 v26, v195, v197
    v_mul_f32 v27, v194, v197
    v_mul_f32 v28, v221, v223
    v_mul_f32 v29, v220, v223
    v_cvt_pk_bf16_f32 v178, v204, -v205
    v_cvt_pk_bf16_f32 v179, v230, -v231
    v_fma_f32 v194, v194, v196, -v26
    v_fma_f32 v195, v195, v196, v27
    v_fma_f32 v220, v220, v222, -v28
    v_fma_f32 v221, v221, v222, v29
    v_mul_f32 v30, v209, v189
    v_mul_f32 v31, v208, v189
    v_mul_f32 v26, v235, v215
    v_mul_f32 v27, v234, v215
    v_cvt_pk_bf16_f32 v118, v194, v195
    v_cvt_pk_bf16_f32 v119, v220, v221
    v_fma_f32 v208, v208, v188, -v30
    v_fma_f32 v209, v209, v188, v31
    v_fma_f32 v234, v234, v214, -v26
    v_fma_f32 v235, v235, v214, v27
    v_mul_f32 v28, v193, v197
    v_mul_f32 v29, v192, v197
    v_mul_f32 v30, v219, v223
    v_mul_f32 v31, v218, v223
    v_cvt_pk_bf16_f32 v180, v208, -v209
    v_cvt_pk_bf16_f32 v181, v234, -v235
    v_fma_f32 v192, v192, v196, -v28
    v_fma_f32 v193, v193, v196, v29
    v_fma_f32 v218, v218, v222, -v30
    v_fma_f32 v219, v219, v222, v31
    v_mul_f32 v26, v205, v189
    v_mul_f32 v27, v204, v189
    v_mul_f32 v28, v231, v215
    v_mul_f32 v29, v230, v215
    v_cvt_pk_bf16_f32 v120, v192, v193
    v_cvt_pk_bf16_f32 v121, v218, v219
    v_fma_f32 v204, v204, v188, -v26
    v_fma_f32 v205, v205, v188, v27
    v_fma_f32 v230, v230, v214, -v28
    v_fma_f32 v231, v231, v214, v29
    v_mul_f32 v30, v195, v197
    v_mul_f32 v31, v194, v197
    v_mul_f32 v26, v221, v223
    v_mul_f32 v27, v220, v223
    v_cvt_pk_bf16_f32 v182, v204, -v205
    v_cvt_pk_bf16_f32 v183, v230, -v231
    v_fma_f32 v194, v194, v196, -v30
    v_fma_f32 v195, v195, v196, v31
    v_fma_f32 v220, v220, v222, -v26
    v_fma_f32 v221, v221, v222, v27
    v_mul_f32 v28, v193, v197
    v_mul_f32 v29, v192, v197
    v_mul_f32 v30, v219, v223
    v_mul_f32 v31, v218, v223
    v_cvt_pk_bf16_f32 v122, v194, v195
    v_cvt_pk_bf16_f32 v123, v220, v221
    v_fma_f32 v192, v192, v196, -v28
    v_fma_f32 v193, v193, v196, v29
    v_fma_f32 v218, v218, v222, -v30
    v_fma_f32 v219, v219, v222, v31
    v_mul_f32 v26, v195, v197
    v_mul_f32 v27, v194, v197
    v_mul_f32 v28, v221, v223
    v_mul_f32 v29, v220, v223
    v_cvt_pk_bf16_f32 v124, v192, v193
    v_cvt_pk_bf16_f32 v125, v218, v219
    v_fma_f32 v194, v194, v196, -v26
    v_fma_f32 v195, v195, v196, v27
    v_fma_f32 v220, v220, v222, -v28
    v_fma_f32 v221, v221, v222, v29
    v_cvt_pk_bf16_f32 v126, v194, v195
    v_cvt_pk_bf16_f32 v127, v220, v221
    s_waitcnt vmcnt(0)
    s_mov_b32 s52, 2097152
Ltag_20:
    v_readfirstlane_b32 s8, v18
    v_readfirstlane_b32 s9, v19
    s_nop 0
    s_cmp_lg_u32 s8, 0
    s_cbranch_scc1 Ltagd_21
    s_sub_u32 s52, s52, 1
    s_cbranch_scc1 Ltagd_21
    global_load_dwordx2 v[18:19], v16, s[10:11] sc1
    s_waitcnt vmcnt(0)
    s_branch Ltag_20
Ltagd_21:
    s_mov_b64 exec, 1
    v_mov_b32 v18, s8
    v_mov_b32 v19, s9
    buffer_store_dwordx2 v[18:19], v16, s[4:7], s22 offen sc1
    s_mov_b64 exec, -1
    s_getreg_b32 s53, hwreg(HW_REG_XCC_ID, 0, 3)
    s_getreg_b32 s54, hwreg(HW_REG_HW_ID, 8, 8)
    s_lshl_b32 s53, s53, 8
    s_or_b32 s53, s53, s54
    s_lshl_b32 s53, s53, 7
    s_add_u32 s53, s53, 18087936
    s_mov_b32 s52, 16
    s_mov_b64 exec, 1
Lcw_22:
    buffer_load_dwordx2 v[20:21], v16, s[4:7], s53 offen sc1
    s_waitcnt vmcnt(0)
    v_cmp_eq_u64 vcc, s[8:9], v[20:21]
    s_nop 1
    s_cmp_lg_u64 vcc, 0
    s_cbranch_scc1 Lcwd_23
    s_sub_u32 s52, s52, 1
    s_cbranch_scc0 Lcw_22
Lcwd_23:
    s_mov_b64 exec, -1
    buffer_load_dwordx2 v[20:21], v23, s[4:7], s23 offen sc1
    ds_write_addtid_b32 v64 offset:0
    ds_write_addtid_b32 v65 offset:256
    ds_write_addtid_b32 v66 offset:528
    ds_write_addtid_b32 v67 offset:784
    ds_write_addtid_b32 v68 offset:1056
    ds_write_addtid_b32 v69 offset:1312
    ds_write_addtid_b32 v70 offset:1584
    ds_write_addtid_b32 v71 offset:1840
    ds_write_addtid_b32 v72 offset:2112
    ds_write_addtid_b32 v73 offset:2368
    ds_write_addtid_b32 v74 offset:2640
    ds_write_addtid_b32 v75 offset:2896
    ds_write_addtid_b32 v76 offset:3168
    ds_write_addtid_b32 v77 offset:3424
    ds_write_addtid_b32 v78 offset:3696
    ds_write_addtid_b32 v79 offset:3952
    ds_write_addtid_b32 v80 offset:4224
    ds_write_addtid_b32 v81 offset:4480
    ds_write_addtid_b32 v82 offset:4752
    ds_write_addtid_b32 v83 offset:5008
    ds_write_addtid_b32 v84 offset:5280
    ds_write_addtid_b32 v85 offset:5536
    ds_write_addtid_b32 v86 offset:5808
    ds_write_addtid_b32 v87 offset:6064
    ds_write_addtid_b32 v88 offset:6336
    ds_write_addtid_b32 v89 offset:6592
    ds_write_addtid_b32 v90 offset:6864
    ds_write_addtid_b32 v91 offset:7120
    ds_write_addtid_b32 v92 offset:7392
    ds_write_addtid_b32 v93 offset:7648
    ds_write_addtid_b32 v94 offset:7920
    ds_write_addtid_b32 v95 offset:8176
    ds_write_addtid_b32 v96 offset:8448
    ds_write_addtid_b32 v97 offset:8704
    ds_write_addtid_b32 v98 offset:8976
    ds_write_addtid_b32 v99 offset:9232
    ds_write_addtid_b32 v100 offset:9504
    ds_write_addtid_b32 v101 offset:9760
    ds_write_addtid_b32 v102 offset:10032
    ds_write_addtid_b32 v103 offset:10288
    ds_write_addtid_b32 v104 offset:10560
    ds_write_addtid_b32 v105 offset:10816
    ds_write_addtid_b32 v106 offset:11088
    ds_write_addtid_b32 v107 offset:11344
    ds_write_addtid_b32 v108 offset:11616
    ds_write_addtid_b32 v109 offset:11872
    ds_write_addtid_b32 v110 offset:12144
    ds_write_addtid_b32 v111 offset:12400
    ds_write_addtid_b32 v112 offset:12672
    ds_write_addtid_b32 v113 offset:12928
    ds_write_addtid_b32 v114 offset:13200
    ds_write_addtid_b32 v115 offset:13456
    ds_write_addtid_b32 v116 offset:13728
    ds_write_addtid_b32 v117 offset:13984
    ds_write_addtid_b32 v118 offset:14256
    ds_write_addtid_b32 v119 offset:14512
    ds_write_addtid_b32 v120 offset:14784
    ds_write_addtid_b32 v121 offset:15040
    ds_write_addtid_b32 v122 offset:15312
    ds_write_addtid_b32 v123 offset:15568
    ds_write_addtid_b32 v124 offset:15840
    ds_write_addtid_b32 v125 offset:16096
    ds_write_addtid_b32 v126 offset:16368
    ds_write_addtid_b32 v127 offset:16624
    ds_read_b128 v[184:187], v15 offset:0
    ds_read_b128 v[188:191], v15 offset:32
    ds_read_b128 v[192:195], v15 offset:64
    ds_read_b128 v[196:199], v15 offset:96
    ds_read_b128 v[200:203], v15 offset:128
    ds_read_b128 v[204:207], v15 offset:160
    ds_read_b128 v[208:211], v15 offset:192
    ds_read_b128 v[212:215], v15 offset:224
    ds_read_b128 v[216:219], v15 offset:256
    ds_read_b128 v[220:223], v15 offset:288
    ds_read_b128 v[224:227], v15 offset:320
    ds_read_b128 v[228:231], v15 offset:352
    ds_read_b128 v[232:235], v15 offset:384
    ds_read_b128 v[236:239], v15 offset:416
    ds_read_b128 v[240:243], v15 offset:448
    ds_read_b128 v[244:247], v15 offset:480
    ds_write_addtid_b32 v128 offset:0
    ds_write_addtid_b32 v129 offset:256
    ds_write_addtid_b32 v130 offset:528
    ds_write_addtid_b32 v131 offset:784
    ds_write_addtid_b32 v132 offset:1056
    ds_write_addtid_b32 v133 offset:1312
    ds_write_addtid_b32 v134 offset:1584
    ds_write_addtid_b32 v135 offset:1840
    ds_write_addtid_b32 v136 offset:4224
    ds_write_addtid_b32 v137 offset:4480
    ds_write_addtid_b32 v138 offset:4752
    ds_write_addtid_b32 v139 offset:5008
    ds_write_addtid_b32 v140 offset:5280
    ds_write_addtid_b32 v141 offset:5536
    ds_write_addtid_b32 v142 offset:5808
    ds_write_addtid_b32 v143 offset:6064
    ds_write_addtid_b32 v144 offset:8448
    ds_write_addtid_b32 v145 offset:8704
    ds_write_addtid_b32 v146 offset:2112
    ds_write_addtid_b32 v147 offset:2368
    ds_write_addtid_b32 v148 offset:2640
    ds_write_addtid_b32 v149 offset:2896
    ds_write_addtid_b32 v150 offset:3168
    ds_write_addtid_b32 v151 offset:3424
    ds_write_addtid_b32 v152 offset:3696
    ds_write_addtid_b32 v153 offset:3952
    ds_write_addtid_b32 v154 offset:6336
    ds_write_addtid_b32 v155 offset:6592
    ds_write_addtid_b32 v156 offset:6864
    ds_write_addtid_b32 v157 offset:7120
    ds_write_addtid_b32 v158 offset:7392
    ds_write_addtid_b32 v159 offset:7648
    ds_write_addtid_b32 v160 offset:7920
    ds_write_addtid_b32 v161 offset:8176
    ds_write_addtid_b32 v162 offset:10560
    ds_write_addtid_b32 v163 offset:10816
    ds_write_addtid_b32 v164 offset:11088
    ds_write_addtid_b32 v165 offset:11344
    ds_write_addtid_b32 v166 offset:11616
    ds_write_addtid_b32 v167 offset:11872
    ds_write_addtid_b32 v168 offset:8976
    ds_write_addtid_b32 v169 offset:9232
    ds_write_addtid_b32 v170 offset:9504
    ds_write_addtid_b32 v171 offset:9760
    ds_write_addtid_b32 v172 offset:10032
    ds_write_addtid_b32 v173 offset:10288
    ds_write_addtid_b32 v174 offset:12672
    ds_write_addtid_b32 v175 offset:12928
    ds_write_addtid_b32 v176 offset:13200
    ds_write_addtid_b32 v177 offset:13456
    ds_write_addtid_b32 v178 offset:13728
    ds_write_addtid_b32 v179 offset:13984
    ds_write_addtid_b32 v180 offset:15312
    ds_write_addtid_b32 v181 offset:15568
    ds_write_addtid_b32 v182 offset:15840
    ds_write_addtid_b32 v183 offset:16096
    ds_read_b128 v[64:67], v15 offset:0
    ds_read_b128 v[68:71], v15 offset:32
    ds_read_b128 v[72:75], v15 offset:64
    ds_read_b128 v[76:79], v15 offset:96
    ds_read_b128 v[80:83], v15 offset:128
    ds_read_b128 v[84:87], v15 offset:160
    ds_read_b128 v[88:91], v15 offset:192
    ds_read_b128 v[92:95], v15 offset:224
    s_waitcnt vmcnt(0)
    v_cmp_ne_u64 vcc, s[8:9], v[20:21]
    s_nop 1
    s_cmp_eq_u64 vcc, 0
    s_cbranch_scc1 Lxd_24
    s_mov_b64 exec, -1
    s_mov_b32 s52, 2097152
Lpoll_25:
    buffer_load_dwordx2 v[20:21], v23, s[4:7], s23 offen sc1
    s_waitcnt vmcnt(0)
    v_cmp_ne_u64 vcc, s[8:9], v[20:21]
    s_nop 1
    s_and_b64 exec, exec, vcc
    s_cbranch_scc0 Lpolld_26
    s_sub_u32 s52, s52, 1
    s_cbranch_scc1 Lpolld_26
    s_sleep 2
    s_branch Lpoll_25
Lpolld_26:
    s_mov_b64 exec, -1
Lxd_24:
    s_add_u32 m0, s24, 0
    s_nop 0
    buffer_load_dwordx4 v248, s[4:7], s25 offen lds
    s_add_u32 m0, s24, 1024
    s_nop 0
    buffer_load_dwordx4 v249, s[4:7], s25 offen lds
    s_add_u32 m0, s24, 2048
    s_nop 0
    buffer_load_dwordx4 v250, s[4:7], s25 offen lds
    s_waitcnt lgkmcnt(7)
    v_mfma_f32_32x32x16_bf16 v[32:47], v[64:67], v[184:187], 0
    ds_read_b128 v[96:99], v15 offset:256
    s_waitcnt lgkmcnt(7)
    v_mfma_f32_32x32x16_bf16 v[32:47], v[68:71], v[188:191], v[32:47]
    ds_read_b128 v[100:103], v15 offset:288
    s_waitcnt lgkmcnt(7)
    v_mfma_f32_32x32x16_bf16 v[32:47], v[72:75], v[192:195], v[32:47]
    ds_read_b128 v[104:107], v15 offset:320
    s_waitcnt lgkmcnt(7)
    v_mfma_f32_32x32x16_bf16 v[32:47], v[76:79], v[196:199], v[32:47]
    ds_read_b128 v[108:111], v15 offset:352
    s_waitcnt lgkmcnt(7)
    v_mfma_f32_32x32x16_bf16 v[32:47], v[80:83], v[200:203], v[32:47]
    ds_read_b128 v[112:115], v15 offset:384
    s_waitcnt lgkmcnt(7)
    v_mfma_f32_32x32x16_bf16 v[32:47], v[84:87], v[204:207], v[32:47]
    ds_read_b128 v[116:119], v15 offset:416
    s_waitcnt lgkmcnt(7)
    v_mfma_f32_32x32x16_bf16 v[32:47], v[88:91], v[208:211], v[32:47]
    ds_read_b128 v[120:123], v15 offset:448
    s_waitcnt lgkmcnt(7)
    v_mfma_f32_32x32x16_bf16 v[32:47], v[92:95], v[212:215], v[32:47]
    ds_read_b128 v[124:127], v15 offset:480
    s_waitcnt lgkmcnt(7)
    v_mfma_f32_32x32x16_bf16 v[32:47], v[96:99], v[216:219], v[32:47]
    s_waitcnt lgkmcnt(6)
    v_mfma_f32_32x32x16_bf16 v[32:47], v[100:103], v[220:223], v[32:47]
    s_waitcnt lgkmcnt(5)
    v_mfma_f32_32x32x16_bf16 v[32:47], v[104:107], v[224:227], v[32:47]
    s_waitcnt lgkmcnt(4)
    v_mfma_f32_32x32x16_bf16 v[32:47], v[108:111], v[228:231], v[32:47]
    s_waitcnt lgkmcnt(3)
    v_mfma_f32_32x32x16_bf16 v[32:47], v[112:115], v[232:235], v[32:47]
    s_waitcnt lgkmcnt(2)
    v_mfma_f32_32x32x16_bf16 v[32:47], v[116:119], v[236:239], v[32:47]
    s_waitcnt lgkmcnt(1)
    v_mfma_f32_32x32x16_bf16 v[32:47], v[120:123], v[240:243], v[32:47]
    s_waitcnt lgkmcnt(0)
    v_mfma_f32_32x32x16_bf16 v[32:47], v[124:127], v[244:247], v[32:47]
    s_setprio 3
    v_mov_b32 v152, 0
    v_mov_b32 v153, 0
    v_mov_b32 v154, 0
    v_mov_b32 v155, 0
    v_add_u32 v26, s37, v2
    v_add_u32 v27, s38, v2
    s_nop 4
    ds_write_b128 v3, v[32:35] offset:0
    ds_write_b128 v3, v[36:39] offset:1024
    ds_write_b128 v3, v[40:43] offset:2048
    ds_write_b128 v3, v[44:47] offset:3072
    s_waitcnt lgkmcnt(0)
    s_barrier
    ds_read_b128 v[128:131], v4 offset:0
    ds_read_b128 v[132:135], v4 offset:1024
    ds_read_b128 v[136:139], v4 offset:2048
    ds_read_b128 v[140:143], v4 offset:3072
    ds_write_b128 v26, v[152:155]
    ds_write_b128 v26, v[152:155] offset:256
    s_mov_b64 exec, 1
    v_add_f32 v32, v25, v32
    s_mov_b64 exec, -1
    s_waitcnt lgkmcnt(5)
    v_add_f32 v32, v32, v128
    v_add_f32 v33, v33, v129
    v_add_f32 v34, v34, v130
    v_add_f32 v35, v35, v131
    s_waitcnt lgkmcnt(4)
    v_add_f32 v36, v36, v132
    v_add_f32 v37, v37, v133
    v_add_f32 v38, v38, v134
    v_add_f32 v39, v39, v135
    s_waitcnt lgkmcnt(3)
    v_add_f32 v40, v40, v136
    v_add_f32 v41, v41, v137
    v_add_f32 v42, v42, v138
    v_add_f32 v43, v43, v139
    s_waitcnt lgkmcnt(2)
    v_add_f32 v44, v44, v140
    v_add_f32 v45, v45, v141
    v_add_f32 v46, v46, v142
    v_cndmask_b32 v148, v41, v42, s[56:57]
    v_cndmask_b32 v149, v43, v44, s[56:57]
    v_cndmask_b32 v150, v45, v46, s[56:57]
    s_cmp_eq_u32 s14, 1
    s_cbranch_scc1 Lver1_27
    v_cvt_pk_bf16_f32 v172, v46, v46
    v_cvt_pk_bf16_f32 v173, v46, v150
    v_cvt_pk_bf16_f32 v174, v45, v45
    v_cvt_pk_bf16_f32 v175, v45, v45
    v_add_u32 v179, 8316, v5
    ds_write_b128 v5, v[172:175] offset:0
    ds_write2_b32 v179, v172, v173 offset0:0 offset1:1
    ds_write2_b32 v179, v174, v175 offset0:2 offset1:3
    v_cvt_pk_bf16_f32 v160, v39, v38
    v_cvt_pk_bf16_f32 v161, v37, v36
    v_cvt_pk_bf16_f32 v162, v35, v34
    v_cvt_pk_bf16_f32 v163, v33, v32
    v_cvt_pk_bf16_f32 v164, v42, v42
    v_cvt_pk_bf16_f32 v165, v42, v148
    v_cvt_pk_bf16_f32 v166, v41, v41
    v_cvt_pk_bf16_f32 v167, v41, v41
    v_cvt_pk_bf16_f32 v168, v44, v44
    v_cvt_pk_bf16_f32 v169, v44, v149
    v_cvt_pk_bf16_f32 v170, v43, v43
    v_cvt_pk_bf16_f32 v171, v43, v43
    s_mov_b32 exec_lo, 0
    v_cvt_pk_bf16_f32 v160, v36, v35
    v_cvt_pk_bf16_f32 v161, v34, v34
    v_cvt_pk_bf16_f32 v162, v34, v33
    v_cvt_pk_bf16_f32 v163, v32, v32
    v_cvt_pk_bf16_f32 v164, v39, v39
    v_cvt_pk_bf16_f32 v165, v38, v38
    v_cvt_pk_bf16_f32 v166, v38, v37
    v_cvt_pk_bf16_f32 v167, v37, v37
    v_cvt_pk_bf16_f32 v168, v42, v42
    v_cvt_pk_bf16_f32 v169, v41, v41
    v_cvt_pk_bf16_f32 v170, v41, v40
    v_cvt_pk_bf16_f32 v171, v40, v40
    s_mov_b32 exec_lo, -1
    v_add_u32 v176, 11388, v5
    ds_write_b128 v5, v[160:163] offset:3072
    ds_write2_b32 v176, v160, v161 offset0:0 offset1:1
    ds_write2_b32 v176, v162, v163 offset0:2 offset1:3
    v_add_u32 v177, 9852, v6
    ds_write_b128 v6, v[164:167] offset:1536
    ds_write2_b32 v177, v164, v165 offset0:0 offset1:1
    ds_write2_b32 v177, v166, v167 offset0:2 offset1:3
    v_add_u32 v178, 9340, v6
    ds_write_b128 v6, v[168:171] offset:1024
    ds_write2_b32 v178, v168, v169 offset0:0 offset1:1
    ds_write2_b32 v178, v170, v171 offset0:2 offset1:3
    s_mov_b64 exec, 0xf
    v_add_u32 v28, 12412, v27
    ds_write_b128 v27, v[152:155] offset:4096
    ds_write2_b32 v28, v152, v153 offset0:0 offset1:1
    ds_write2_b32 v28, v154, v155 offset0:2 offset1:3
    s_mov_b64 exec, -1
    s_branch Lkend_28
Lver1_27:
    v_cvt_pk_bf16_f32 v172, v46, v46
    v_cvt_pk_bf16_f32 v173, v46, v46
    v_cvt_pk_bf16_f32 v174, v150, v45
    v_cvt_pk_bf16_f32 v175, v45, v45
    v_add_u32 v179, 4156, v5
    ds_write_b64 v5, v[172:173] offset:12472
    ds_write_b64 v5, v[174:175] offset:12480
    ds_write2_b32 v179, v172, v173 offset0:0 offset1:1
    ds_write2_b32 v179, v174, v175 offset0:2 offset1:3
    v_cvt_pk_bf16_f32 v160, v40, v39
    v_cvt_pk_bf16_f32 v161, v38, v37
    v_cvt_pk_bf16_f32 v162, v36, v35
    v_cvt_pk_bf16_f32 v163, v34, v33
    v_cvt_pk_bf16_f32 v164, v42, v42
    v_cvt_pk_bf16_f32 v165, v42, v42
    v_cvt_pk_bf16_f32 v166, v148, v41
    v_cvt_pk_bf16_f32 v167, v41, v41
    v_cvt_pk_bf16_f32 v168, v44, v44
    v_cvt_pk_bf16_f32 v169, v44, v44
    v_cvt_pk_bf16_f32 v170, v149, v43
    v_cvt_pk_bf16_f32 v171, v43, v43
    s_mov_b32 exec_lo, 0
    v_cvt_pk_bf16_f32 v160, v36, v36
    v_cvt_pk_bf16_f32 v161, v35, v34
    v_cvt_pk_bf16_f32 v162, v34, v34
    v_cvt_pk_bf16_f32 v163, v33, v32
    v_cvt_pk_bf16_f32 v164, v39, v39
    v_cvt_pk_bf16_f32 v165, v39, v38
    v_cvt_pk_bf16_f32 v166, v38, v38
    v_cvt_pk_bf16_f32 v167, v37, v37
    v_cvt_pk_bf16_f32 v168, v42, v42
    v_cvt_pk_bf16_f32 v169, v42, v41
    v_cvt_pk_bf16_f32 v170, v41, v41
    v_cvt_pk_bf16_f32 v171, v40, v40
    s_mov_b32 exec_lo, -1
    v_add_u32 v176, 7228, v5
    ds_write_b64 v5, v[160:161] offset:15544
    ds_write_b64 v5, v[162:163] offset:15552
    ds_write2_b32 v176, v160, v161 offset0:0 offset1:1
    ds_write2_b32 v176, v162, v163 offset0:2 offset1:3
    v_add_u32 v177, 5692, v6
    ds_write_b64 v6, v[164:165] offset:14008
    ds_write_b64 v6, v[166:167] offset:14016
    ds_write2_b32 v177, v164, v165 offset0:0 offset1:1
    ds_write2_b32 v177, v166, v167 offset0:2 offset1:3
    v_add_u32 v178, 5180, v6
    ds_write_b64 v6, v[168:169] offset:13496
    ds_write_b64 v6, v[170:171] offset:13504
    ds_write2_b32 v178, v168, v169 offset0:0 offset1:1
    ds_write2_b32 v178, v170, v171 offset0:2 offset1:3
    s_mov_b64 exec, 1
    v_cvt_pk_bf16_f32 v152, v32, 0
    s_mov_b64 exec, 0xf
    v_add_u32 v28, 8252, v27
    ds_write_b64 v27, v[152:153] offset:16568
    ds_write_b64 v27, v[154:155] offset:16576
    ds_write2_b32 v28, v152, v153 offset0:0 offset1:1
    ds_write2_b32 v28, v154, v155 offset0:2 offset1:3
    s_mov_b64 exec, -1
Lkend_28:
    s_waitcnt vmcnt(0) lgkmcnt(0)
    s_barrier
    s_setprio 1
    ds_read_b64 v[64:65], v14 offset:4032
    ds_read_b64 v[66:67], v14 offset:4040
    ds_read_b128 v[72:75], v22 offset:2480
    ds_read_b128 v[76:79], v22 offset:5040
    ds_read_b64 v[68:69], v14 offset:1984
    ds_read_b64 v[70:71], v14 offset:1992
    ds_read_b64 v[80:81], v14 offset:3968
    ds_read_b64 v[82:83], v14 offset:3976
    ds_read_b128 v[88:91], v22 offset:2400
    ds_read_b128 v[92:95], v22 offset:4960
    ds_read_b64 v[84:85], v14 offset:1920
    ds_read_b64 v[86:87], v14 offset:1928
    s_waitcnt lgkmcnt(6)
    v_mfma_f32_32x32x16_bf16 v[32:47], v[64:67], v[72:75], 0
    ds_read_b64 v[96:97], v14 offset:3904
    ds_read_b64 v[98:99], v14 offset:3912
    s_lshl_b32 s52, s3, 12
    v_mfma_f32_32x32x16_bf16 v[48:63], v[64:67], v[76:79], 0
    ds_read_b128 v[104:107], v22 offset:2320
    ds_read_b128 v[108:111], v22 offset:4880
    s_xor_b32 s53, s52, 4096
    v_mfma_f32_32x32x16_bf16 v[48:63], v[68:71], v[72:75], v[48:63]
    ds_read_b64 v[100:101], v14 offset:1856
    ds_read_b64 v[102:103], v14 offset:1864
    s_xor_b32 s54, s52, 8192
    s_waitcnt lgkmcnt(6)
    v_mfma_f32_32x32x16_bf16 v[32:47], v[80:83], v[88:91], v[32:47]
    ds_read_b64 v[112:113], v14 offset:3840
    ds_read_b64 v[114:115], v14 offset:3848
    v_add_u32 v3, s52, v2
    v_mfma_f32_32x32x16_bf16 v[48:63], v[80:83], v[92:95], v[48:63]
    ds_read_b128 v[120:123], v22 offset:2240
    ds_read_b128 v[124:127], v22 offset:4800
    v_add_u32 v4, s53, v2
    v_mfma_f32_32x32x16_bf16 v[48:63], v[84:87], v[88:91], v[48:63]
    ds_read_b64 v[116:117], v14 offset:1792
    ds_read_b64 v[118:119], v14 offset:1800
    v_add_u32 v5, s54, v2
    s_waitcnt lgkmcnt(6)
    v_mfma_f32_32x32x16_bf16 v[32:47], v[96:99], v[104:107], v[32:47]
    ds_read_b64 v[64:65], v14 offset:3776
    ds_read_b64 v[66:67], v14 offset:3784
    v_and_b32 v8, 31, v1
    v_mfma_f32_32x32x16_bf16 v[48:63], v[96:99], v[108:111], v[48:63]
    ds_read_b128 v[72:75], v22 offset:2160
    ds_read_b128 v[76:79], v22 offset:4720
    v_lshrrev_b32 v9, 5, v1
    v_mfma_f32_32x32x16_bf16 v[48:63], v[100:103], v[104:107], v[48:63]
    ds_read_b64 v[68:69], v14 offset:1728
    ds_read_b64 v[70:71], v14 offset:1736
    v_and_b32 v10, 1, v8
    s_waitcnt lgkmcnt(6)
    v_mfma_f32_32x32x16_bf16 v[32:47], v[112:115], v[120:123], v[32:47]
    ds_read_b64 v[80:81], v14 offset:3712
    ds_read_b64 v[82:83], v14 offset:3720
    v_lshlrev_b32 v10, 4, v10
    v_mfma_f32_32x32x16_bf16 v[48:63], v[112:115], v[124:127], v[48:63]
    ds_read_b128 v[88:91], v22 offset:2080
    ds_read_b128 v[92:95], v22 offset:4640
    v_mov_b32 v11, 0x3f80
    v_mfma_f32_32x32x16_bf16 v[48:63], v[116:119], v[120:123], v[48:63]
    ds_read_b64 v[84:85], v14 offset:1664
    ds_read_b64 v[86:87], v14 offset:1672
    v_lshlrev_b32 v10, v10, v11
    s_waitcnt lgkmcnt(6)
    v_mfma_f32_32x32x16_bf16 v[32:47], v[64:67], v[72:75], v[32:47]
    ds_read_b64 v[96:97], v14 offset:3648
    ds_read_b64 v[98:99], v14 offset:3656
    v_lshrrev_b32 v11, 1, v8
    v_mfma_f32_32x32x16_bf16 v[48:63], v[64:67], v[76:79], v[48:63]
    ds_read_b128 v[104:107], v22 offset:2000
    ds_read_b128 v[108:111], v22 offset:4560
    v_lshlrev_b32 v12, 2, v9
    v_mfma_f32_32x32x16_bf16 v[48:63], v[68:71], v[72:75], v[48:63]
    ds_read_b64 v[100:101], v14 offset:1600
    ds_read_b64 v[102:103], v14 offset:1608
    v_sub_u32 v11, v11, v12
    s_waitcnt lgkmcnt(6)
    v_mfma_f32_32x32x16_bf16 v[32:47], v[80:83], v[88:91], v[32:47]
    ds_read_b64 v[112:113], v14 offset:3584
    ds_read_b64 v[114:115], v14 offset:3592
    v_cmp_eq_u32 vcc, 0, v11
    v_mfma_f32_32x32x16_bf16 v[48:63], v[80:83], v[92:95], v[48:63]
    ds_read_b128 v[120:123], v22 offset:1920
    ds_read_b128 v[124:127], v22 offset:4480
    v_cndmask_b32 v24, 0, v10, vcc
    v_mfma_f32_32x32x16_bf16 v[48:63], v[84:87], v[88:91], v[48:63]
    ds_read_b64 v[116:117], v14 offset:1536
    ds_read_b64 v[118:119], v14 offset:1544
    v_cmp_eq_u32 vcc, 1, v11
    s_waitcnt lgkmcnt(6)
    v_mfma_f32_32x32x16_bf16 v[32:47], v[96:99], v[104:107], v[32:47]
    ds_read_b64 v[64:65], v14 offset:3520
    ds_read_b64 v[66:67], v14 offset:3528
    v_cndmask_b32 v25, 0, v10, vcc
    v_mfma_f32_32x32x16_bf16 v[48:63], v[96:99], v[108:111], v[48:63]
    ds_read_b128 v[72:75], v22 offset:1840
    ds_read_b128 v[76:79], v22 offset:4400
    v_cmp_eq_u32 vcc, 2, v11
    v_mfma_f32_32x32x16_bf16 v[48:63], v[100:103], v[104:107], v[48:63]
    ds_read_b64 v[68:69], v14 offset:1472
    ds_read_b64 v[70:71], v14 offset:1480
    v_cndmask_b32 v26, 0, v10, vcc
    s_waitcnt lgkmcnt(6)
    v_mfma_f32_32x32x16_bf16 v[32:47], v[112:115], v[120:123], v[32:47]
    ds_read_b64 v[80:81], v14 offset:3456
    ds_read_b64 v[82:83], v14 offset:3464
    v_cmp_eq_u32 vcc, 3, v11
    v_mfma_f32_32x32x16_bf16 v[48:63], v[112:115], v[124:127], v[48:63]
    ds_read_b128 v[88:91], v22 offset:1760
    ds_read_b128 v[92:95], v22 offset:4320
    v_cndmask_b32 v27, 0, v10, vcc
    v_mfma_f32_32x32x16_bf16 v[48:63], v[116:119], v[120:123], v[48:63]
    ds_read_b64 v[84:85], v14 offset:1408
    ds_read_b64 v[86:87], v14 offset:1416
    v_cmp_eq_u32 vcc, 8, v11
    s_waitcnt lgkmcnt(6)
    v_mfma_f32_32x32x16_bf16 v[32:47], v[64:67], v[72:75], v[32:47]
    ds_read_b64 v[96:97], v14 offset:3392
    ds_read_b64 v[98:99], v14 offset:3400
    v_cndmask_b32 v28, 0, v10, vcc
    v_mfma_f32_32x32x16_bf16 v[48:63], v[64:67], v[76:79], v[48:63]
    ds_read_b128 v[104:107], v22 offset:1680
    ds_read_b128 v[108:111], v22 offset:4240
    v_cmp_eq_u32 vcc, 9, v11
    v_mfma_f32_32x32x16_bf16 v[48:63], v[68:71], v[72:75], v[48:63]
    ds_read_b64 v[100:101], v14 offset:1344
    ds_read_b64 v[102:103], v14 offset:1352
    v_cndmask_b32 v29, 0, v10, vcc
    s_waitcnt lgkmcnt(6)
    v_mfma_f32_32x32x16_bf16 v[32:47], v[80:83], v[88:91], v[32:47]
    ds_read_b64 v[112:113], v14 offset:3328
    ds_read_b64 v[114:115], v14 offset:3336
    v_cmp_eq_u32 vcc, 10, v11
    v_mfma_f32_32x32x16_bf16 v[48:63], v[80:83], v[92:95], v[48:63]
    ds_read_b128 v[120:123], v22 offset:1600
    ds_read_b128 v[124:127], v22 offset:4160
    v_cndmask_b32 v30, 0, v10, vcc
    v_mfma_f32_32x32x16_bf16 v[48:63], v[84:87], v[88:91], v[48:63]
    ds_read_b64 v[116:117], v14 offset:1280
    ds_read_b64 v[118:119], v14 offset:1288
    v_cmp_eq_u32 vcc, 11, v11
    s_waitcnt lgkmcnt(6)
    v_mfma_f32_32x32x16_bf16 v[32:47], v[96:99], v[104:107], v[32:47]
    ds_read_b64 v[64:65], v14 offset:3264
    ds_read_b64 v[66:67], v14 offset:3272
    v_cndmask_b32 v31, 0, v10, vcc
    v_mfma_f32_32x32x16_bf16 v[48:63], v[96:99], v[108:111], v[48:63]
    ds_read_b128 v[72:75], v22 offset:1520
    ds_read_b128 v[76:79], v22 offset:4080
    v_lshlrev_b32 v6, 2, v8
    v_mfma_f32_32x32x16_bf16 v[48:63], v[100:103], v[104:107], v[48:63]
    ds_read_b64 v[68:69], v14 offset:1216
    ds_read_b64 v[70:71], v14 offset:1224
    v_and_b32 v9, 7, v1
    s_waitcnt lgkmcnt(6)
    v_mfma_f32_32x32x16_bf16 v[32:47], v[112:115], v[120:123], v[32:47]
    ds_read_b64 v[80:81], v14 offset:3200
    ds_read_b64 v[82:83], v14 offset:3208
    v_mul_u32_u24 v9, 128, v9
    v_mfma_f32_32x32x16_bf16 v[48:63], v[112:115], v[124:127], v[48:63]
    ds_read_b128 v[88:91], v22 offset:1440
    ds_read_b128 v[92:95], v22 offset:4000
    v_mov_b32 v13, v255
    v_mfma_f32_32x32x16_bf16 v[48:63], v[116:119], v[120:123], v[48:63]
    ds_read_b64 v[84:85], v14 offset:1152
    ds_read_b64 v[86:87], v14 offset:1160
    v_xor_b32 v12, 64, v252
    s_waitcnt lgkmcnt(6)
    v_mfma_f32_32x32x16_bf16 v[32:47], v[64:67], v[72:75], v[32:47]
    ds_read_b64 v[96:97], v14 offset:3136
    ds_read_b64 v[98:99], v14 offset:3144
    v_mfma_f32_32x32x16_bf16 v[48:63], v[64:67], v[76:79], v[48:63]
    ds_read_b128 v[104:107], v22 offset:1360
    ds_read_b128 v[108:111], v22 offset:3920
    v_mfma_f32_32x32x16_bf16 v[48:63], v[68:71], v[72:75], v[48:63]
    ds_read_b64 v[100:101], v14 offset:1088
    ds_read_b64 v[102:103], v14 offset:1096
    s_waitcnt lgkmcnt(6)
    v_mfma_f32_32x32x16_bf16 v[32:47], v[80:83], v[88:91], v[32:47]
    ds_read_b64 v[112:113], v14 offset:3072
    ds_read_b64 v[114:115], v14 offset:3080
    v_mfma_f32_32x32x16_bf16 v[48:63], v[80:83], v[92:95], v[48:63]
    ds_read_b128 v[120:123], v22 offset:1280
    ds_read_b128 v[124:127], v22 offset:3840
    v_mfma_f32_32x32x16_bf16 v[48:63], v[84:87], v[88:91], v[48:63]
    ds_read_b64 v[116:117], v14 offset:1024
    ds_read_b64 v[118:119], v14 offset:1032
    s_waitcnt lgkmcnt(6)
    v_mfma_f32_32x32x16_bf16 v[32:47], v[96:99], v[104:107], v[32:47]
    ds_read_b64 v[64:65], v14 offset:3008
    ds_read_b64 v[66:67], v14 offset:3016
    v_mfma_f32_32x32x16_bf16 v[48:63], v[96:99], v[108:111], v[48:63]
    ds_read_b128 v[72:75], v22 offset:1200
    ds_read_b128 v[76:79], v22 offset:3760
    v_mfma_f32_32x32x16_bf16 v[48:63], v[100:103], v[104:107], v[48:63]
    ds_read_b64 v[68:69], v14 offset:960
    ds_read_b64 v[70:71], v14 offset:968
    s_waitcnt lgkmcnt(6)
    v_mfma_f32_32x32x16_bf16 v[32:47], v[112:115], v[120:123], v[32:47]
    ds_read_b64 v[80:81], v14 offset:2944
    ds_read_b64 v[82:83], v14 offset:2952
    v_mfma_f32_32x32x16_bf16 v[48:63], v[112:115], v[124:127], v[48:63]
    ds_read_b128 v[88:91], v22 offset:1120
    ds_read_b128 v[92:95], v22 offset:3680
    v_mfma_f32_32x32x16_bf16 v[48:63], v[116:119], v[120:123], v[48:63]
    ds_read_b64 v[84:85], v14 offset:896
    ds_read_b64 v[86:87], v14 offset:904
    s_waitcnt lgkmcnt(6)
    v_mfma_f32_32x32x16_bf16 v[32:47], v[64:67], v[72:75], v[32:47]
    ds_read_b64 v[96:97], v14 offset:2880
    ds_read_b64 v[98:99], v14 offset:2888
    v_mfma_f32_32x32x16_bf16 v[48:63], v[64:67], v[76:79], v[48:63]
    ds_read_b128 v[104:107], v22 offset:1040
    ds_read_b128 v[108:111], v22 offset:3600
    v_mfma_f32_32x32x16_bf16 v[48:63], v[68:71], v[72:75], v[48:63]
    ds_read_b64 v[100:101], v14 offset:832
    ds_read_b64 v[102:103], v14 offset:840
    s_waitcnt lgkmcnt(6)
    v_mfma_f32_32x32x16_bf16 v[32:47], v[80:83], v[88:91], v[32:47]
    ds_read_b64 v[112:113], v14 offset:2816
    ds_read_b64 v[114:115], v14 offset:2824
    v_mfma_f32_32x32x16_bf16 v[48:63], v[80:83], v[92:95], v[48:63]
    ds_read_b128 v[120:123], v22 offset:960
    ds_read_b128 v[124:127], v22 offset:3520
    v_mfma_f32_32x32x16_bf16 v[48:63], v[84:87], v[88:91], v[48:63]
    ds_read_b64 v[116:117], v14 offset:768
    ds_read_b64 v[118:119], v14 offset:776
    s_waitcnt lgkmcnt(6)
    v_mfma_f32_32x32x16_bf16 v[32:47], v[96:99], v[104:107], v[32:47]
    ds_read_b64 v[64:65], v14 offset:2752
    ds_read_b64 v[66:67], v14 offset:2760
    v_mfma_f32_32x32x16_bf16 v[48:63], v[96:99], v[108:111], v[48:63]
    ds_read_b128 v[72:75], v22 offset:880
    ds_read_b128 v[76:79], v22 offset:3440
    v_mfma_f32_32x32x16_bf16 v[48:63], v[100:103], v[104:107], v[48:63]
    ds_read_b64 v[68:69], v14 offset:704
    ds_read_b64 v[70:71], v14 offset:712
    s_waitcnt lgkmcnt(6)
    v_mfma_f32_32x32x16_bf16 v[32:47], v[112:115], v[120:123], v[32:47]
    ds_read_b64 v[80:81], v14 offset:2688
    ds_read_b64 v[82:83], v14 offset:2696
    v_mfma_f32_32x32x16_bf16 v[48:63], v[112:115], v[124:127], v[48:63]
    ds_read_b128 v[88:91], v22 offset:800
    ds_read_b128 v[92:95], v22 offset:3360
    v_mfma_f32_32x32x16_bf16 v[48:63], v[116:119], v[120:123], v[48:63]
    ds_read_b64 v[84:85], v14 offset:640
    ds_read_b64 v[86:87], v14 offset:648
    s_waitcnt lgkmcnt(6)
    v_mfma_f32_32x32x16_bf16 v[32:47], v[64:67], v[72:75], v[32:47]
    ds_read_b64 v[96:97], v14 offset:2624
    ds_read_b64 v[98:99], v14 offset:2632
    v_mfma_f32_32x32x16_bf16 v[48:63], v[64:67], v[76:79], v[48:63]
    ds_read_b128 v[104:107], v22 offset:720
    ds_read_b128 v[108:111], v22 offset:3280
    v_mfma_f32_32x32x16_bf16 v[48:63], v[68:71], v[72:75], v[48:63]
    ds_read_b64 v[100:101], v14 offset:576
    ds_read_b64 v[102:103], v14 offset:584
    s_waitcnt lgkmcnt(6)
    v_mfma_f32_32x32x16_bf16 v[32:47], v[80:83], v[88:91], v[32:47]
    ds_read_b64 v[112:113], v14 offset:2560
    ds_read_b64 v[114:115], v14 offset:2568
    v_mfma_f32_32x32x16_bf16 v[48:63], v[80:83], v[92:95], v[48:63]
    ds_read_b128 v[120:123], v22 offset:640
    ds_read_b128 v[124:127], v22 offset:3200
    v_mfma_f32_32x32x16_bf16 v[48:63], v[84:87], v[88:91], v[48:63]
    ds_read_b64 v[116:117], v14 offset:512
    ds_read_b64 v[118:119], v14 offset:520
    s_waitcnt lgkmcnt(6)
    v_mfma_f32_32x32x16_bf16 v[32:47], v[96:99], v[104:107], v[32:47]
    ds_read_b64 v[64:65], v14 offset:2496
    ds_read_b64 v[66:67], v14 offset:2504
    v_mfma_f32_32x32x16_bf16 v[48:63], v[96:99], v[108:111], v[48:63]
    ds_read_b128 v[72:75], v22 offset:560
    ds_read_b128 v[76:79], v22 offset:3120
    v_mfma_f32_32x32x16_bf16 v[48:63], v[100:103], v[104:107], v[48:63]
    ds_read_b64 v[68:69], v14 offset:448
    ds_read_b64 v[70:71], v14 offset:456
    s_waitcnt lgkmcnt(6)
    v_mfma_f32_32x32x16_bf16 v[32:47], v[112:115], v[120:123], v[32:47]
    ds_read_b64 v[80:81], v14 offset:2432
    ds_read_b64 v[82:83], v14 offset:2440
    v_mfma_f32_32x32x16_bf16 v[48:63], v[112:115], v[124:127], v[48:63]
    ds_read_b128 v[88:91], v22 offset:480
    ds_read_b128 v[92:95], v22 offset:3040
    v_mfma_f32_32x32x16_bf16 v[48:63], v[116:119], v[120:123], v[48:63]
    ds_read_b64 v[84:85], v14 offset:384
    ds_read_b64 v[86:87], v14 offset:392
    s_waitcnt lgkmcnt(6)
    v_mfma_f32_32x32x16_bf16 v[32:47], v[64:67], v[72:75], v[32:47]
    ds_read_b64 v[96:97], v14 offset:2368
    ds_read_b64 v[98:99], v14 offset:2376
    v_mfma_f32_32x32x16_bf16 v[48:63], v[64:67], v[76:79], v[48:63]
    ds_read_b128 v[104:107], v22 offset:400
    ds_read_b128 v[108:111], v22 offset:2960
    v_mfma_f32_32x32x16_bf16 v[48:63], v[68:71], v[72:75], v[48:63]
    ds_read_b64 v[100:101], v14 offset:320
    ds_read_b64 v[102:103], v14 offset:328
    s_waitcnt lgkmcnt(6)
    v_mfma_f32_32x32x16_bf16 v[32:47], v[80:83], v[88:91], v[32:47]
    ds_read_b64 v[112:113], v14 offset:2304
    ds_read_b64 v[114:115], v14 offset:2312
    v_mfma_f32_32x32x16_bf16 v[48:63], v[80:83], v[92:95], v[48:63]
    ds_read_b128 v[120:123], v22 offset:320
    ds_read_b128 v[124:127], v22 offset:2880
    v_mfma_f32_32x32x16_bf16 v[48:63], v[84:87], v[88:91], v[48:63]
    ds_read_b64 v[116:117], v14 offset:256
    ds_read_b64 v[118:119], v14 offset:264
    s_waitcnt lgkmcnt(6)
    v_mfma_f32_32x32x16_bf16 v[32:47], v[96:99], v[104:107], v[32:47]
    ds_read_b64 v[64:65], v14 offset:2240
    ds_read_b64 v[66:67], v14 offset:2248
    v_mfma_f32_32x32x16_bf16 v[48:63], v[96:99], v[108:111], v[48:63]
    ds_read_b128 v[72:75], v22 offset:240
    ds_read_b128 v[76:79], v22 offset:2800
    v_mfma_f32_32x32x16_bf16 v[48:63], v[100:103], v[104:107], v[48:63]
    ds_read_b64 v[68:69], v14 offset:192
    ds_read_b64 v[70:71], v14 offset:200
    s_waitcnt lgkmcnt(6)
    v_mfma_f32_32x32x16_bf16 v[32:47], v[112:115], v[120:123], v[32:47]
    ds_read_b64 v[80:81], v14 offset:2176
    ds_read_b64 v[82:83], v14 offset:2184
    v_mfma_f32_32x32x16_bf16 v[48:63], v[112:115], v[124:127], v[48:63]
    ds_read_b128 v[88:91], v22 offset:160
    ds_read_b128 v[92:95], v22 offset:2720
    v_mfma_f32_32x32x16_bf16 v[48:63], v[116:119], v[120:123], v[48:63]
    ds_read_b64 v[84:85], v14 offset:128
    ds_read_b64 v[86:87], v14 offset:136
    s_waitcnt lgkmcnt(6)
    v_mfma_f32_32x32x16_bf16 v[32:47], v[64:67], v[72:75], v[32:47]
    ds_read_b64 v[96:97], v14 offset:2112
    ds_read_b64 v[98:99], v14 offset:2120
    v_mfma_f32_32x32x16_bf16 v[48:63], v[64:67], v[76:79], v[48:63]
    ds_read_b128 v[104:107], v22 offset:80
    ds_read_b128 v[108:111], v22 offset:2640
    v_mfma_f32_32x32x16_bf16 v[48:63], v[68:71], v[72:75], v[48:63]
    ds_read_b64 v[100:101], v14 offset:64
    ds_read_b64 v[102:103], v14 offset:72
    s_waitcnt lgkmcnt(6)
    v_mfma_f32_32x32x16_bf16 v[32:47], v[80:83], v[88:91], v[32:47]
    ds_read_b64 v[112:113], v14 offset:2048
    ds_read_b64 v[114:115], v14 offset:2056
    v_mfma_f32_32x32x16_bf16 v[48:63], v[80:83], v[92:95], v[48:63]
    ds_read_b128 v[120:123], v22 offset:0
    ds_read_b128 v[124:127], v22 offset:2560
    v_mfma_f32_32x32x16_bf16 v[48:63], v[84:87], v[88:91], v[48:63]
    ds_read_b64 v[116:117], v14 offset:0
    ds_read_b64 v[118:119], v14 offset:8
    s_waitcnt lgkmcnt(6)
    v_mfma_f32_32x32x16_bf16 v[32:47], v[96:99], v[104:107], v[32:47]
    v_mfma_f32_32x32x16_bf16 v[48:63], v[96:99], v[108:111], v[48:63]
    v_mfma_f32_32x32x16_bf16 v[48:63], v[100:103], v[104:107], v[48:63]
    s_waitcnt lgkmcnt(0)
    v_mfma_f32_32x32x16_bf16 v[32:47], v[112:115], v[120:123], v[32:47]
    v_mfma_f32_32x32x16_bf16 v[48:63], v[112:115], v[124:127], v[48:63]
    v_mfma_f32_32x32x16_bf16 v[48:63], v[116:119], v[120:123], v[48:63]
    s_setprio 3
    s_nop 11
    s_cmp_eq_u32 s14, 1
    s_cbranch_scc1 Lck1_29
    ds_write_b128 v3, v[48:51] offset:20992
    ds_write_b128 v3, v[52:55] offset:22016
    ds_write_b128 v3, v[56:59] offset:23040
    ds_write_b128 v3, v[60:63] offset:24064
    s_waitcnt lgkmcnt(0)
    s_barrier
    ds_read_b128 v[64:67], v4 offset:20992
    ds_read_b128 v[68:71], v4 offset:22016
    ds_read_b128 v[72:75], v4 offset:23040
    ds_read_b128 v[76:79], v4 offset:24064
    s_waitcnt lgkmcnt(0)
    s_barrier
    v_add_f32 v32, v32, v64
    v_add_f32 v33, v33, v65
    v_add_f32 v34, v34, v66
    v_add_f32 v35, v35, v67
    v_add_f32 v36, v36, v68
    v_add_f32 v37, v37, v69
    v_add_f32 v38, v38, v70
    v_add_f32 v39, v39, v71
    v_add_f32 v40, v40, v72
    v_add_f32 v41, v41, v73
    v_add_f32 v42, v42, v74
    v_add_f32 v43, v43, v75
    v_add_f32 v44, v44, v76
    v_add_f32 v45, v45, v77
    v_add_f32 v46, v46, v78
    v_add_f32 v47, v47, v79
    v_cvt_pk_bf16_f32 v96, v32, v33
    v_cvt_pk_bf16_f32 v97, v34, v35
    v_cvt_pk_bf16_f32 v98, v36, v37
    v_cvt_pk_bf16_f32 v99, v38, v39
    v_cvt_pk_bf16_f32 v100, v40, v41
    v_cvt_pk_bf16_f32 v101, v42, v43
    v_cvt_pk_bf16_f32 v102, v44, v45
    v_cvt_pk_bf16_f32 v103, v46, v47
    s_branch Lcj_30
Lck1_29:
    ds_write_b128 v3, v[32:35] offset:20992
    ds_write_b128 v3, v[36:39] offset:22016
    ds_write_b128 v3, v[40:43] offset:23040
    ds_write_b128 v3, v[44:47] offset:24064
    s_waitcnt lgkmcnt(0)
    s_barrier
    ds_read_b128 v[64:67], v4 offset:20992
    ds_read_b128 v[68:71], v4 offset:22016
    ds_read_b128 v[72:75], v4 offset:23040
    ds_read_b128 v[76:79], v4 offset:24064
    s_waitcnt lgkmcnt(0)
    s_barrier
    v_add_f32 v48, v48, v64
    v_add_f32 v49, v49, v65
    v_add_f32 v50, v50, v66
    v_add_f32 v51, v51, v67
    v_add_f32 v52, v52, v68
    v_add_f32 v53, v53, v69
    v_add_f32 v54, v54, v70
    v_add_f32 v55, v55, v71
    v_add_f32 v56, v56, v72
    v_add_f32 v57, v57, v73
    v_add_f32 v58, v58, v74
    v_add_f32 v59, v59, v75
    v_add_f32 v60, v60, v76
    v_add_f32 v61, v61, v77
    v_add_f32 v62, v62, v78
    v_add_f32 v63, v63, v79
    v_cvt_pk_bf16_f32 v96, v48, v49
    v_cvt_pk_bf16_f32 v97, v50, v51
    v_cvt_pk_bf16_f32 v98, v52, v53
    v_cvt_pk_bf16_f32 v99, v54, v55
    v_cvt_pk_bf16_f32 v100, v56, v57
    v_cvt_pk_bf16_f32 v101, v58, v59
    v_cvt_pk_bf16_f32 v102, v60, v61
    v_cvt_pk_bf16_f32 v103, v62, v63
Lcj_30:
    s_nop 1
    v_permlane32_swap_b32 v96, v98
    v_permlane32_swap_b32 v97, v99
    v_permlane32_swap_b32 v100, v102
    v_permlane32_swap_b32 v101, v103
    buffer_store_dwordx4 v[96:99], v7, s[4:7], s26 offen offset:0 sc1
    buffer_store_dwordx4 v[100:103], v7, s[4:7], s26 offen offset:1024 sc1
    s_waitcnt vmcnt(0)
    s_mov_b64 exec, 1
    v_mov_b32 v18, s8
    v_mov_b32 v19, s9
    buffer_store_dwordx2 v[18:19], v16, s[4:7], s27 offen sc1
    s_mov_b64 exec, -1
    s_add_u32 m0, s32, 0
    s_mov_b32 s52, 0
    buffer_load_dwordx4 v251, s[40:43], s52 offen lds
    s_waitcnt vmcnt(1)
    s_add_u32 m0, s32, 4096
    s_mov_b32 s52, 28672
    buffer_load_dwordx4 v251, s[40:43], s52 offen lds
    s_waitcnt vmcnt(1)
    s_add_u32 m0, s32, 8192
    s_mov_b32 s52, 57344
    buffer_load_dwordx4 v251, s[40:43], s52 offen lds
    s_waitcnt vmcnt(1)
    s_add_u32 m0, s32, 12288
    s_mov_b32 s52, 86016
    buffer_load_dwordx4 v251, s[40:43], s52 offen lds
    s_waitcnt vmcnt(1)
    s_add_u32 m0, s32, 16384
    s_mov_b32 s52, 114688
    buffer_load_dwordx4 v251, s[40:43], s52 offen lds
    s_waitcnt vmcnt(1)
    s_add_u32 m0, s32, 20480
    s_mov_b32 s52, 143360
    buffer_load_dwordx4 v251, s[40:43], s52 offen lds
    s_waitcnt vmcnt(1)
    s_add_u32 m0, s32, 24576
    s_mov_b32 s52, 172032
    buffer_load_dwordx4 v251, s[40:43], s52 offen lds
    s_waitcnt vmcnt(1)
    s_add_u32 m0, s32, 28672
    s_mov_b32 s52, 200704
    buffer_load_dwordx4 v251, s[40:43], s52 offen lds
    s_waitcnt vmcnt(1)
    s_add_u32 m0, s32, 32768
    s_mov_b32 s52, 229376
    buffer_load_dwordx4 v251, s[40:43], s52 offen lds
    s_waitcnt vmcnt(1)
    s_add_u32 m0, s32, 36864
    s_mov_b32 s52, 258048
    buffer_load_dwordx4 v251, s[40:43], s52 offen lds
    s_waitcnt vmcnt(1)
    s_add_u32 m0, s32, 40960
    s_mov_b32 s52, 286720
    buffer_load_dwordx4 v251, s[40:43], s52 offen lds
    s_waitcnt vmcnt(1)
    s_add_u32 m0, s32, 45056
    s_mov_b32 s52, 315392
    buffer_load_dwordx4 v251, s[40:43], s52 offen lds
    s_waitcnt vmcnt(1)
    s_add_u32 m0, s32, 49152
    s_mov_b32 s52, 344064
    buffer_load_dwordx4 v251, s[40:43], s52 offen lds
    s_waitcnt vmcnt(1)
    s_add_u32 m0, s32, 53248
    s_mov_b32 s52, 372736
    buffer_load_dwordx4 v251, s[40:43], s52 offen lds
    s_waitcnt vmcnt(1)
    s_add_u32 m0, s32, 57344
    s_mov_b32 s52, 401408
    buffer_load_dwordx4 v251, s[40:43], s52 offen lds
    s_waitcnt vmcnt(1)
    s_waitcnt vmcnt(0)
    s_barrier
    ds_read_b64_tr_b16 v[64:65], v252 offset:0
    ds_read_b64_tr_b16 v[66:67], v252 offset:512
    ds_read_b64_tr_b16 v[128:129], v12 offset:0
    ds_read_b64_tr_b16 v[130:131], v12 offset:512
    ds_read_b64_tr_b16 v[68:69], v12 offset:1792
    ds_read_b64_tr_b16 v[70:71], v12 offset:2304
    ds_read_b64_tr_b16 v[132:133], v252 offset:1792
    ds_read_b64_tr_b16 v[134:135], v252 offset:2304
    ds_read_b64_tr_b16 v[72:73], v252 offset:3584
    ds_read_b64_tr_b16 v[74:75], v252 offset:4096
    ds_read_b64_tr_b16 v[136:137], v12 offset:3584
    ds_read_b64_tr_b16 v[138:139], v12 offset:4096
    ds_read_b64_tr_b16 v[76:77], v12 offset:5376
    ds_read_b64_tr_b16 v[78:79], v12 offset:5888
    ds_read_b64_tr_b16 v[140:141], v252 offset:5376
    ds_read_b64_tr_b16 v[142:143], v252 offset:5888
    ds_read_b64_tr_b16 v[80:81], v252 offset:7168
    ds_read_b64_tr_b16 v[82:83], v252 offset:7680
    ds_read_b64_tr_b16 v[144:145], v12 offset:7168
    ds_read_b64_tr_b16 v[146:147], v12 offset:7680
    ds_read_b64_tr_b16 v[84:85], v12 offset:8960
    ds_read_b64_tr_b16 v[86:87], v12 offset:9472
    ds_read_b64_tr_b16 v[148:149], v252 offset:8960
    ds_read_b64_tr_b16 v[150:151], v252 offset:9472
    ds_read_b64_tr_b16 v[88:89], v252 offset:10752
    ds_read_b64_tr_b16 v[90:91], v252 offset:11264
    ds_read_b64_tr_b16 v[152:153], v12 offset:10752
    ds_read_b64_tr_b16 v[154:155], v12 offset:11264
    ds_read_b64_tr_b16 v[92:93], v12 offset:12544
    ds_read_b64_tr_b16 v[94:95], v12 offset:13056
    ds_read_b64_tr_b16 v[156:157], v252 offset:12544
    ds_read_b64_tr_b16 v[158:159], v252 offset:13056
    ds_read_b64_tr_b16 v[96:97], v252 offset:14336
    ds_read_b64_tr_b16 v[98:99], v252 offset:14848
    ds_read_b64_tr_b16 v[160:161], v12 offset:14336
    ds_read_b64_tr_b16 v[162:163], v12 offset:14848
    ds_read_b64_tr_b16 v[100:101], v12 offset:16128
    ds_read_b64_tr_b16 v[102:103], v12 offset:16640
    ds_read_b64_tr_b16 v[164:165], v252 offset:16128
    ds_read_b64_tr_b16 v[166:167], v252 offset:16640
    ds_read_b64_tr_b16 v[104:105], v252 offset:17920
    ds_read_b64_tr_b16 v[106:107], v252 offset:18432
    ds_read_b64_tr_b16 v[168:169], v12 offset:17920
    ds_read_b64_tr_b16 v[170:171], v12 offset:18432
    ds_read_b64_tr_b16 v[108:109], v12 offset:19712
    ds_read_b64_tr_b16 v[110:111], v12 offset:20224
    ds_read_b64_tr_b16 v[172:173], v252 offset:19712
    ds_read_b64_tr_b16 v[174:175], v252 offset:20224
    ds_read_b64_tr_b16 v[112:113], v252 offset:21504
    ds_read_b64_tr_b16 v[114:115], v252 offset:22016
    ds_read_b64_tr_b16 v[176:177], v12 offset:21504
    ds_read_b64_tr_b16 v[178:179], v12 offset:22016
    ds_read_b64_tr_b16 v[116:117], v12 offset:23296
    ds_read_b64_tr_b16 v[118:119], v12 offset:23808
    ds_read_b64_tr_b16 v[180:181], v252 offset:23296
    ds_read_b64_tr_b16 v[182:183], v252 offset:23808
    ds_read_b64_tr_b16 v[120:121], v252 offset:25088
    ds_read_b64_tr_b16 v[122:123], v252 offset:25600
    ds_read_b64_tr_b16 v[184:185], v12 offset:25088
    ds_read_b64_tr_b16 v[186:187], v12 offset:25600
    ds_read_b64_tr_b16 v[124:125], v12 offset:26880
    ds_read_b64_tr_b16 v[126:127], v12 offset:27392
    ds_read_b64_tr_b16 v[188:189], v252 offset:26880
    ds_read_b64_tr_b16 v[190:191], v252 offset:27392
    v_and_b32 v10, 3, v1
    v_mul_u32_u24 v10, 0x3c6ef2, v10
    v_add_u32 v10, 0x9e3779b1, v10
    s_xor_b32 s52, s8, s9
    v_mul_lo_u32 v10, s52, v10
    v_and_b32 v10, 0x9fff0000, v10
    v_or_b32 v15, 0x20000000, v10
    s_mov_b32 s52, 18022400
    s_mov_b64 exec, -1
    s_mov_b32 s53, 2097152
Lpoll_31:
    buffer_load_dwordx2 v[18:19], v254, s[4:7], s52 offen sc1
    s_waitcnt vmcnt(0)
    v_cmp_ne_u64 vcc, s[8:9], v[18:19]
    s_nop 1
    s_and_b64 exec, exec, vcc
    s_cbranch_scc0 Lpolld_32
    s_sub_u32 s53, s53, 1
    s_cbranch_scc1 Lpolld_32
    s_sleep 8
    s_branch Lpoll_31
Lpolld_32:
    s_mov_b64 exec, -1
    buffer_load_dwordx4 v[192:195], v253, s[4:7], s34 offen offset:0
    buffer_load_dwordx4 v[196:199], v253, s[4:7], s34 offen offset:1024
    buffer_load_dword v8, v6, s[4:7], s35 offen
    s_waitcnt vmcnt(0) lgkmcnt(0)
    v_mfma_f32_32x32x16_bf16 v[48:63], v[192:195], v[24:27], 0
    v_mfma_f32_32x32x16_bf16 v[48:63], v[196:199], v[28:31], v[48:63]
    v_and_b32 v67, 0xffff, v67
    v_and_b32 v71, 0xffff, v71
    v_and_b32 v75, 0xffff, v75
    v_and_b32 v79, 0xffff, v79
    v_and_b32 v83, 0xffff, v83
    v_and_b32 v87, 0xffff, v87
    v_and_b32 v91, 0xffff, v91
    v_and_b32 v95, 0xffff, v95
    v_and_b32 v99, 0xffff, v99
    v_and_b32 v103, 0xffff, v103
    v_and_b32 v107, 0xffff, v107
    v_and_b32 v111, 0xffff, v111
    v_and_b32 v115, 0xffff, v115
    v_and_b32 v119, 0xffff, v119
    v_and_b32 v123, 0xffff, v123
    v_and_b32 v127, 0xffff, v127
    v_and_b32 v131, 0xffff, v131
    v_and_b32 v135, 0xffff, v135
    v_and_b32 v139, 0xffff, v139
    v_and_b32 v143, 0xffff, v143
    v_and_b32 v147, 0xffff, v147
    v_and_b32 v151, 0xffff, v151
    v_and_b32 v155, 0xffff, v155
    v_and_b32 v159, 0xffff, v159
    v_and_b32 v163, 0xffff, v163
    v_and_b32 v167, 0xffff, v167
    v_and_b32 v171, 0xffff, v171
    v_and_b32 v175, 0xffff, v175
    v_and_b32 v179, 0xffff, v179
    v_and_b32 v183, 0xffff, v183
    v_and_b32 v187, 0xffff, v187
    v_and_b32 v191, 0xffff, v191
    s_barrier
    s_add_u32 s64, s30, 0
    s_add_u32 s65, s30, 4096
    s_add_u32 s66, s30, 8192
    s_add_u32 s67, s30, 12288
    s_mov_b64 exec, 0xff
    s_mov_b32 s62, 2097152
Lpoll_35:
    buffer_load_dwordx2 v[10:11], v9, s[4:7], s36 offen sc1
    s_waitcnt vmcnt(0)
    v_cmp_ne_u64 vcc, s[8:9], v[10:11]
    s_nop 1
    s_and_b64 exec, exec, vcc
    s_cbranch_scc0 Lpolld_36
    s_sub_u32 s62, s62, 1
    s_cbranch_scc1 Lpolld_36
    s_sleep 2
    s_branch Lpoll_35
Lpolld_36:
    s_mov_b64 exec, -1
    s_mov_b32 s62, 2097152
Lol_33:
    buffer_load_dwordx4 v[192:195], v2, s[4:7], s64 offen offset:0 sc1
    buffer_load_dwordx4 v[196:199], v2, s[4:7], s64 offen offset:1024 sc1
    buffer_load_dwordx4 v[200:203], v2, s[4:7], s64 offen offset:2048 sc1
    buffer_load_dwordx4 v[204:207], v2, s[4:7], s64 offen offset:3072 sc1
    buffer_load_dwordx4 v[208:211], v2, s[4:7], s65 offen offset:0 sc1
    buffer_load_dwordx4 v[212:215], v2, s[4:7], s65 offen offset:1024 sc1
    buffer_load_dwordx4 v[216:219], v2, s[4:7], s65 offen offset:2048 sc1
    buffer_load_dwordx4 v[220:223], v2, s[4:7], s65 offen offset:3072 sc1
    buffer_load_dwordx4 v[224:227], v2, s[4:7], s66 offen offset:0 sc1
    buffer_load_dwordx4 v[228:231], v2, s[4:7], s66 offen offset:1024 sc1
    buffer_load_dwordx4 v[232:235], v2, s[4:7], s66 offen offset:2048 sc1
    buffer_load_dwordx4 v[236:239], v2, s[4:7], s66 offen offset:3072 sc1
    buffer_load_dwordx4 v[240:243], v2, s[4:7], s67 offen offset:0 sc1
    buffer_load_dwordx4 v[244:247], v2, s[4:7], s67 offen offset:1024 sc1
    buffer_load_dwordx4 v[248:251], v2, s[4:7], s67 offen offset:2048 sc1
    buffer_load_dwordx4 v[252:255], v2, s[4:7], s67 offen offset:3072 sc1
    s_mov_b64 s[70:71], -1
    s_waitcnt vmcnt(15)
    v_mfma_f32_32x32x16_bf16 v[16:31], v[128:131], v[192:195], 0
    v_cmp_eq_u32_sdwa vcc, v195, v15 src0_sel:WORD_1 src1_sel:WORD_1
    v_mfma_f32_32x32x16_bf16 v[32:47], v[64:67], v[192:195], 0
    s_nop 0
    s_and_b64 s[70:71], s[70:71], vcc
    s_waitcnt vmcnt(14)
    v_mfma_f32_32x32x16_bf16 v[16:31], v[132:135], v[196:199], v[16:31]
    v_cmp_eq_u32_sdwa vcc, v199, v15 src0_sel:WORD_1 src1_sel:WORD_1
    v_mfma_f32_32x32x16_bf16 v[32:47], v[68:71], v[196:199], v[32:47]
    s_nop 0
    s_and_b64 s[70:71], s[70:71], vcc
    s_waitcnt vmcnt(13)
    v_mfma_f32_32x32x16_bf16 v[16:31], v[136:139], v[200:203], v[16:31]
    v_cmp_eq_u32_sdwa vcc, v203, v15 src0_sel:WORD_1 src1_sel:WORD_1
    v_mfma_f32_32x32x16_bf16 v[32:47], v[72:75], v[200:203], v[32:47]
    s_nop 0
    s_and_b64 s[70:71], s[70:71], vcc
    s_waitcnt vmcnt(12)
    v_mfma_f32_32x32x16_bf16 v[16:31], v[140:143], v[204:207], v[16:31]
    v_cmp_eq_u32_sdwa vcc, v207, v15 src0_sel:WORD_1 src1_sel:WORD_1
    v_mfma_f32_32x32x16_bf16 v[32:47], v[76:79], v[204:207], v[32:47]
    s_nop 0
    s_and_b64 s[70:71], s[70:71], vcc
    s_waitcnt vmcnt(11)
    v_mfma_f32_32x32x16_bf16 v[16:31], v[144:147], v[208:211], v[16:31]
    v_cmp_eq_u32_sdwa vcc, v211, v15 src0_sel:WORD_1 src1_sel:WORD_1
    v_mfma_f32_32x32x16_bf16 v[32:47], v[80:83], v[208:211], v[32:47]
    s_nop 0
    s_and_b64 s[70:71], s[70:71], vcc
    s_waitcnt vmcnt(10)
    v_mfma_f32_32x32x16_bf16 v[16:31], v[148:151], v[212:215], v[16:31]
    v_cmp_eq_u32_sdwa vcc, v215, v15 src0_sel:WORD_1 src1_sel:WORD_1
    v_mfma_f32_32x32x16_bf16 v[32:47], v[84:87], v[212:215], v[32:47]
    s_nop 0
    s_and_b64 s[70:71], s[70:71], vcc
    s_waitcnt vmcnt(9)
    v_mfma_f32_32x32x16_bf16 v[16:31], v[152:155], v[216:219], v[16:31]
    v_cmp_eq_u32_sdwa vcc, v219, v15 src0_sel:WORD_1 src1_sel:WORD_1
    v_mfma_f32_32x32x16_bf16 v[32:47], v[88:91], v[216:219], v[32:47]
    s_nop 0
    s_and_b64 s[70:71], s[70:71], vcc
    s_waitcnt vmcnt(8)
    v_mfma_f32_32x32x16_bf16 v[16:31], v[156:159], v[220:223], v[16:31]
    v_cmp_eq_u32_sdwa vcc, v223, v15 src0_sel:WORD_1 src1_sel:WORD_1
    v_mfma_f32_32x32x16_bf16 v[32:47], v[92:95], v[220:223], v[32:47]
    s_nop 0
    s_and_b64 s[70:71], s[70:71], vcc
    s_waitcnt vmcnt(7)
    v_mfma_f32_32x32x16_bf16 v[16:31], v[160:163], v[224:227], v[16:31]
    v_cmp_eq_u32_sdwa vcc, v227, v15 src0_sel:WORD_1 src1_sel:WORD_1
    v_mfma_f32_32x32x16_bf16 v[32:47], v[96:99], v[224:227], v[32:47]
    s_nop 0
    s_and_b64 s[70:71], s[70:71], vcc
    s_waitcnt vmcnt(6)
    v_mfma_f32_32x32x16_bf16 v[16:31], v[164:167], v[228:231], v[16:31]
    v_cmp_eq_u32_sdwa vcc, v231, v15 src0_sel:WORD_1 src1_sel:WORD_1
    v_mfma_f32_32x32x16_bf16 v[32:47], v[100:103], v[228:231], v[32:47]
    s_nop 0
    s_and_b64 s[70:71], s[70:71], vcc
    s_waitcnt vmcnt(5)
    v_mfma_f32_32x32x16_bf16 v[16:31], v[168:171], v[232:235], v[16:31]
    v_cmp_eq_u32_sdwa vcc, v235, v15 src0_sel:WORD_1 src1_sel:WORD_1
    v_mfma_f32_32x32x16_bf16 v[32:47], v[104:107], v[232:235], v[32:47]
    s_nop 0
    s_and_b64 s[70:71], s[70:71], vcc
    s_waitcnt vmcnt(4)
    v_mfma_f32_32x32x16_bf16 v[16:31], v[172:175], v[236:239], v[16:31]
    v_cmp_eq_u32_sdwa vcc, v239, v15 src0_sel:WORD_1 src1_sel:WORD_1
    v_mfma_f32_32x32x16_bf16 v[32:47], v[108:111], v[236:239], v[32:47]
    s_nop 0
    s_and_b64 s[70:71], s[70:71], vcc
    s_waitcnt vmcnt(3)
    v_mfma_f32_32x32x16_bf16 v[16:31], v[176:179], v[240:243], v[16:31]
    v_cmp_eq_u32_sdwa vcc, v243, v15 src0_sel:WORD_1 src1_sel:WORD_1
    v_mfma_f32_32x32x16_bf16 v[32:47], v[112:115], v[240:243], v[32:47]
    s_nop 0
    s_and_b64 s[70:71], s[70:71], vcc
    s_waitcnt vmcnt(2)
    v_mfma_f32_32x32x16_bf16 v[16:31], v[180:183], v[244:247], v[16:31]
    v_cmp_eq_u32_sdwa vcc, v247, v15 src0_sel:WORD_1 src1_sel:WORD_1
    v_mfma_f32_32x32x16_bf16 v[32:47], v[116:119], v[244:247], v[32:47]
    s_nop 0
    s_and_b64 s[70:71], s[70:71], vcc
    s_waitcnt vmcnt(1)
    v_mfma_f32_32x32x16_bf16 v[16:31], v[184:187], v[248:251], v[16:31]
    v_cmp_eq_u32_sdwa vcc, v251, v15 src0_sel:WORD_1 src1_sel:WORD_1
    v_mfma_f32_32x32x16_bf16 v[32:47], v[120:123], v[248:251], v[32:47]
    s_nop 0
    s_and_b64 s[70:71], s[70:71], vcc
    s_waitcnt vmcnt(0)
    v_mfma_f32_32x32x16_bf16 v[16:31], v[188:191], v[252:255], v[16:31]
    v_cmp_eq_u32_sdwa vcc, v255, v15 src0_sel:WORD_1 src1_sel:WORD_1
    v_mfma_f32_32x32x16_bf16 v[32:47], v[124:127], v[252:255], v[32:47]
    s_nop 0
    s_and_b64 s[70:71], s[70:71], vcc
    s_cmp_eq_u64 s[70:71], -1
    s_cbranch_scc1 Lok_34
    s_sub_u32 s62, s62, 1
    s_cbranch_scc0 Lol_33
Lok_34:
    s_nop 7
    ds_write_b128 v3, v[16:19] offset:0
    ds_write_b128 v3, v[20:23] offset:1024
    ds_write_b128 v3, v[24:27] offset:2048
    ds_write_b128 v3, v[28:31] offset:3072
    v_sub_f32 v32, v32, v48
    v_sub_f32 v33, v33, v49
    v_sub_f32 v34, v34, v50
    v_sub_f32 v35, v35, v51
    v_sub_f32 v36, v36, v52
    v_sub_f32 v37, v37, v53
    v_sub_f32 v38, v38, v54
    v_sub_f32 v39, v39, v55
    v_sub_f32 v40, v40, v56
    v_sub_f32 v41, v41, v57
    v_sub_f32 v42, v42, v58
    v_sub_f32 v43, v43, v59
    v_sub_f32 v44, v44, v60
    v_sub_f32 v45, v45, v61
    v_sub_f32 v46, v46, v62
    v_sub_f32 v47, v47, v63
    s_waitcnt lgkmcnt(0)
    s_barrier
    ds_read_b128 v[64:67], v5 offset:0
    ds_read_b128 v[68:71], v5 offset:1024
    ds_read_b128 v[72:75], v5 offset:2048
    ds_read_b128 v[76:79], v5 offset:3072
    s_waitcnt lgkmcnt(3)
    v_add_f32 v32, v32, v64
    v_add_f32 v33, v33, v65
    v_add_f32 v34, v34, v66
    v_add_f32 v35, v35, v67
    v_fma_f32 v32, v32, v8, v48
    v_fma_f32 v33, v33, v8, v49
    v_fma_f32 v34, v34, v8, v50
    v_fma_f32 v35, v35, v8, v51
    v_cvt_pk_bf16_f32 v96, v32, v33
    v_cvt_pk_bf16_f32 v97, v34, v35
    s_waitcnt lgkmcnt(2)
    v_add_f32 v36, v36, v68
    v_add_f32 v37, v37, v69
    v_add_f32 v38, v38, v70
    v_add_f32 v39, v39, v71
    v_fma_f32 v36, v36, v8, v52
    v_fma_f32 v37, v37, v8, v53
    v_fma_f32 v38, v38, v8, v54
    v_fma_f32 v39, v39, v8, v55
    v_cvt_pk_bf16_f32 v98, v36, v37
    v_cvt_pk_bf16_f32 v99, v38, v39
    s_nop 0
    v_permlane32_swap_b32 v96, v98
    v_permlane32_swap_b32 v97, v99
    buffer_store_dwordx4 v[96:99], v13, s[44:47], s33 offen offset:0
    s_waitcnt lgkmcnt(1)
    v_add_f32 v40, v40, v72
    v_add_f32 v41, v41, v73
    v_add_f32 v42, v42, v74
    v_add_f32 v43, v43, v75
    v_fma_f32 v40, v40, v8, v56
    v_fma_f32 v41, v41, v8, v57
    v_fma_f32 v42, v42, v8, v58
    v_fma_f32 v43, v43, v8, v59
    v_cvt_pk_bf16_f32 v100, v40, v41
    v_cvt_pk_bf16_f32 v101, v42, v43
    s_waitcnt lgkmcnt(0)
    v_add_f32 v44, v44, v76
    v_add_f32 v45, v45, v77
    v_add_f32 v46, v46, v78
    v_add_f32 v47, v47, v79
    v_fma_f32 v44, v44, v8, v60
    v_fma_f32 v45, v45, v8, v61
    v_fma_f32 v46, v46, v8, v62
    v_fma_f32 v47, v47, v8, v63
    v_cvt_pk_bf16_f32 v102, v44, v45
    v_cvt_pk_bf16_f32 v103, v46, v47
    s_nop 0
    v_permlane32_swap_b32 v100, v102
    v_permlane32_swap_b32 v101, v103
    buffer_store_dwordx4 v[100:103], v13, s[44:47], s33 offen offset:32
    s_endpgm
Lexit_5:
    s_endpgm
.p2align 4
Lcode_end:
.section .rodata,"a"
.p2align 6
.amdhsa_kernel gated_mix__mha_block__ssm_conv_s4__prompt_kernel
  .amdhsa_next_free_vgpr 256
  .amdhsa_next_free_sgpr 102
  .amdhsa_accum_offset 256
  .amdhsa_group_segment_fixed_size 0
  .amdhsa_kernarg_size 128
  .amdhsa_user_sgpr_count 2
  .amdhsa_user_sgpr_kernarg_segment_ptr 1
  .amdhsa_system_sgpr_workgroup_id_x 1
.end_amdhsa_kernel
```
